```python
import torch

def _softmax(x, axis=-1):
    return torch.softmax(x, dim=axis)
def _gelu(x):
    return torch.nn.functional.gelu(x, approximate="tanh")
def _silu(x):
    return torch.nn.functional.silu(x)
def _sigmoid(x):
    return torch.sigmoid(x)
def _layernorm(x, axis=-1, eps=1e-5):
    m = x.mean(dim=axis, keepdim=True)
    v = x.var(dim=axis, keepdim=True, unbiased=False)
    return (x - m) / torch.sqrt(v + eps)
def _scatter_add(tgt, idx, src, axis=0):
    return tgt.clone().index_add_(axis, idx, src)
def _segment_sum(src, seg, n):
    out = torch.zeros((n,) + src.shape[1:], dtype=src.dtype)
    return out.index_add_(0, seg, src)
def _pad(x, pw):
    flat = tuple(v for pair in reversed(pw) for v in pair)
    return torch.nn.functional.pad(x, flat)

kernel_name = 'parallel_sum__linear_kernel_hedgehog__dense_activation_gelu__prompt'

def setup_inputs():

    _w = (lambda a: (lambda t: t.to(torch.bfloat16) if t.is_floating_point() else t)(torch.as_tensor(a)))
    def _A_setup():
        B, S, D, H = 1, 2048, 1024, 32
        Dh = D // H
        return {
            "x": _w((lambda *s: torch.randn(*s, dtype=torch.bfloat16) * 0.05)(B, S, D)),
            "wqkv": _w((lambda *s: torch.randn(*s, dtype=torch.bfloat16) * 0.2)(D, 3 * D)),
            "w_phi": _w((lambda *s: torch.randn(*s, dtype=torch.bfloat16) * 0.2)(H, Dh, Dh) * (Dh ** -0.5)),
            "wo": _w((lambda *s: torch.randn(*s, dtype=torch.bfloat16) * 0.05)(D, D)),
        }
    _A_in = _A_setup()

    def _B_setup():
        B, S, D, F = 1, 2048, 1024, 3584
        return {
            "x": _w((lambda *s: torch.randn(*s, dtype=torch.bfloat16) * 0.05)(B, S, D)),
            "w1": _w((lambda *s: torch.randn(*s, dtype=torch.bfloat16) * 0.8)(D, F) * (D ** -0.5)),
            "b1": _w((lambda *s: torch.randn(*s, dtype=torch.bfloat16) * 0.8)(F) * 0.01),
            "w2": _w((lambda *s: torch.randn(*s, dtype=torch.bfloat16) * 0.2)(F, D) * (F ** -0.5)),
            "b2": _w((lambda *s: torch.randn(*s, dtype=torch.bfloat16) * 0.2)(D) * 0.01),
        }
    _B_in = _B_setup()

    return {
        "A_x": _A_in["x"],
        "A_wqkv": _A_in["wqkv"],
        "A_w_phi": _A_in["w_phi"],
        "A_wo": _A_in["wo"],
        "B_x": _B_in["x"],
        "B_w1": _B_in["w1"],
        "B_b1": _B_in["b1"],
        "B_w2": _B_in["w2"],
        "B_b2": _B_in["b2"],
    }

def reference(A_x, A_wqkv, A_w_phi, A_wo, B_x, B_w1, B_b1, B_w2, B_b2):
    def _A_ref(x, wqkv, w_phi, wo):
        B, S, D = x.shape
        H = 32; Dh = D // H
        qkv = (lambda x, *d: x.permute(*d))((x @ wqkv).reshape(B, S, 3, H, Dh), 2, 0, 3, 1, 4)
        q, k, v = qkv[0], qkv[1], qkv[2]
        pq = torch.einsum("bhsd,hdf->bhsf", q, w_phi)
        pk = torch.einsum("bhsd,hdf->bhsf", k, w_phi)
        phi_q = torch.concatenate([_softmax(pq, axis=-1), _softmax(-pq, axis=-1)], axis=-1)
        phi_k = torch.concatenate([_softmax(pk, axis=-1), _softmax(-pk, axis=-1)], axis=-1)
        kv = torch.einsum("bhsf,bhsd->bhfd", phi_k, v)
        z  = torch.einsum("bhsf->bhf", phi_k)
        num = torch.einsum("bhqf,bhfd->bhqd", phi_q, kv)
        den = torch.einsum("bhqf,bhf->bhq", phi_q, z)[..., None] + 1e-6
        o = num / den
        return (lambda x, *d: x.permute(*d))(o, 0, 2, 1, 3).reshape(B, S, D) @ wo

    def _B_ref(x, w1, b1, w2, b2):
        h = torch.einsum("bsd,df->bsf", x, w1) + b1
        h = _gelu(h)
        return torch.einsum("bsf,fd->bsd", h, w2) + b2

    x = A_x
    xn = _layernorm(x, axis=-1)
    return x + _A_ref(xn, A_wqkv, A_w_phi, A_wo) + _B_ref(xn, B_w1, B_b1, B_w2, B_b2)
```

```asm
; @launch kernel=gemm1_kernel grid=(256,1,1) block=(512,1,1) lds=131072
; @launch kernel=gemm2_kernel grid=(256,1,1) block=(512,1,1) lds=135168
.amdgcn_target "amdgcn-amd-amdhsa--gfx950"
.text
.globl gemm1_kernel
.p2align 8
.type gemm1_kernel,@function
gemm1_kernel:
    s_cmp_ge_u32 s2, 256
    s_cbranch_scc1 g1_done
    s_load_dwordx2 s[4:5], s[0:1], 88
    s_load_dwordx2 s[6:7], s[0:1], 8
    s_load_dwordx2 s[30:31], s[0:1], 40
    s_load_dwordx2 s[32:33], s[0:1], 16
    s_load_dwordx2 s[34:35], s[0:1], 48
    s_load_dwordx2 s[44:45], s[0:1], 24
    s_load_dwordx2 s[48:49], s[0:1], 56
    s_load_dwordx2 s[50:51], s[0:1], 80
    s_load_dwordx2 s[56:57], s[0:1], 0
    v_and_b32 v1, 63, v0
    v_lshrrev_b32 v2, 6, v0
    s_nop 0
    v_readfirstlane_b32 s20, v2
    v_and_b32 v3, 15, v1
    v_lshrrev_b32 v4, 4, v1
    s_and_b32 s21, s2, 7
    s_lshr_b32 s22, s2, 3
    s_and_b32 s23, s21, 1
    s_lshl_b32 s23, s23, 2
    s_and_b32 s24, s22, 3
    s_add_u32 s23, s23, s24
    s_lshr_b32 s24, s22, 2
    s_lshr_b32 s25, s21, 1
    s_lshl_b32 s25, s25, 2
    s_and_b32 s26, s24, 3
    s_add_u32 s25, s25, s26
    s_lshr_b32 s21, s20, 1
    s_and_b32 s22, s20, 1
    s_lshl_b32 s27, s20, 11
    v_lshrrev_b32 v5, 2, v1
    s_lshl_b32 s28, s23, 8
    s_lshl_b32 s29, s20, 5
    s_add_u32 s28, s28, s29
    v_add_u32 v5, s28, v5
    v_lshlrev_b32 v5, 11, v5
    v_lshrrev_b32 v6, 1, v4
    v_xor_b32 v7, v6, v4
    v_and_b32 v7, 1, v7
    v_lshl_or_b32 v6, v7, 1, v6
    v_and_b32 v7, 3, v1
    v_xor_b32 v7, v7, v6
    v_lshl_add_u32 v8, v7, 4, v5
    v_add_u32 v9, 32768, v8
    v_bfe_u32 v5, v1, 2, 2
    v_lshrrev_b32 v6, 1, v5
    v_xor_b32 v7, v6, v5
    v_and_b32 v7, 1, v7
    v_lshl_or_b32 v6, v7, 1, v6
    v_xor_b32 v5, v6, v4
    s_lshl_b32 s28, s21, 6
    v_add_u32 v6, s28, v3
    v_lshlrev_b32 v6, 6, v6
    v_lshl_add_u32 v16, v5, 4, v6
    v_bfe_u32 v5, v1, 2, 2
    v_and_b32 v6, 1, v4
    v_lshl_or_b32 v6, v6, 2, v5
    v_lshl_add_u32 v5, v4, 3, v5
    v_lshlrev_b32 v5, 9, v5
    v_and_b32 v7, 3, v1
    v_lshl_add_u32 v5, v7, 3, v5
    v_add_u32 v5, 0x10000, v5
    s_waitcnt lgkmcnt(0)
    s_mov_b32 s8, s4
    s_mov_b32 s9, s5
    s_and_b32 s9, s9, 0xffff
    s_mov_b32 s10, 0x400000
    s_mov_b32 s11, 0x00020000
    v_mov_b32 v10, 0
    s_bfe_u32 s28, s2, 0x20001
    s_lshl_b32 s28, s28, 3
    s_add_u32 s28, s28, s24
    s_lshl_b32 s28, s28, 3
    s_lshl_b32 s29, s23, 8
    s_add_u32 s28, s28, s29
    s_add_u32 s28, s28, s20
    s_lshl_b32 s28, s28, 11
    v_lshl_add_u32 v10, v1, 4, s28
    s_mov_b32 s56, s56
    s_mov_b32 s57, s57
    s_and_b32 s57, s57, 0xffff
    s_mov_b32 s58, 0x400000
    s_mov_b32 s59, 0x00020000
    buffer_load_dwordx4 v[128:131], v10, s[56:59], 0 offen offset:0
    buffer_load_dwordx4 v[132:135], v10, s[56:59], 0 offen offset:1024
    s_waitcnt vmcnt(0)
    s_mov_b32 s52, s50
    s_mov_b32 s53, s51
    s_and_b32 s53, s53, 0xffff
    s_mov_b32 s54, 0x100
    s_mov_b32 s55, 0x00020000
    s_lshl_b32 s28, s23, 5
    v_mov_b32 v11, s28
    s_movk_i32 s29, 4096
    v_lshlrev_b32 v176, 16, v128
    v_and_b32 v177, 0xffff0000, v128
    v_lshlrev_b32 v178, 16, v129
    v_and_b32 v179, 0xffff0000, v129
    v_lshlrev_b32 v180, 16, v130
    v_and_b32 v181, 0xffff0000, v130
    v_lshlrev_b32 v182, 16, v131
    v_and_b32 v183, 0xffff0000, v131
    v_lshlrev_b32 v184, 16, v132
    v_and_b32 v185, 0xffff0000, v132
    v_lshlrev_b32 v186, 16, v133
    v_and_b32 v187, 0xffff0000, v133
    v_lshlrev_b32 v188, 16, v134
    v_and_b32 v189, 0xffff0000, v134
    v_lshlrev_b32 v190, 16, v135
    v_and_b32 v191, 0xffff0000, v135
    v_add_f32 v192, v176, v177
    v_add_f32 v192, v192, v178
    v_add_f32 v192, v192, v179
    v_add_f32 v192, v192, v180
    v_add_f32 v192, v192, v181
    v_add_f32 v192, v192, v182
    v_add_f32 v192, v192, v183
    v_add_f32 v192, v192, v184
    v_add_f32 v192, v192, v185
    v_add_f32 v192, v192, v186
    v_add_f32 v192, v192, v187
    v_add_f32 v192, v192, v188
    v_add_f32 v192, v192, v189
    v_add_f32 v192, v192, v190
    v_add_f32 v192, v192, v191
    s_nop 1
    v_add_f32_dpp v192, v192, v192 quad_perm:[1,0,3,2] row_mask:0xf bank_mask:0xf
    s_nop 1
    v_add_f32_dpp v192, v192, v192 quad_perm:[2,3,0,1] row_mask:0xf bank_mask:0xf
    s_nop 1
    v_add_f32_dpp v192, v192, v192 row_half_mirror row_mask:0xf bank_mask:0xf
    s_nop 1
    v_add_f32_dpp v192, v192, v192 row_mirror row_mask:0xf bank_mask:0xf
    v_mov_b32 v194, v192
    s_nop 1
    v_permlane16_swap_b32 v192, v194
    s_nop 1
    v_add_f32 v192, v192, v194
    v_mov_b32 v194, v192
    s_nop 1
    v_permlane32_swap_b32 v192, v194
    s_nop 1
    v_add_f32 v192, v192, v194
    v_mul_f32 v192, 0x3a800000, v192
    v_sub_f32 v195, v176, v192
    v_mul_f32 v193, v195, v195
    v_sub_f32 v195, v177, v192
    v_fmac_f32 v193, v195, v195
    v_sub_f32 v195, v178, v192
    v_fmac_f32 v193, v195, v195
    v_sub_f32 v195, v179, v192
    v_fmac_f32 v193, v195, v195
    v_sub_f32 v195, v180, v192
    v_fmac_f32 v193, v195, v195
    v_sub_f32 v195, v181, v192
    v_fmac_f32 v193, v195, v195
    v_sub_f32 v195, v182, v192
    v_fmac_f32 v193, v195, v195
    v_sub_f32 v195, v183, v192
    v_fmac_f32 v193, v195, v195
    v_sub_f32 v195, v184, v192
    v_fmac_f32 v193, v195, v195
    v_sub_f32 v195, v185, v192
    v_fmac_f32 v193, v195, v195
    v_sub_f32 v195, v186, v192
    v_fmac_f32 v193, v195, v195
    v_sub_f32 v195, v187, v192
    v_fmac_f32 v193, v195, v195
    v_sub_f32 v195, v188, v192
    v_fmac_f32 v193, v195, v195
    v_sub_f32 v195, v189, v192
    v_fmac_f32 v193, v195, v195
    v_sub_f32 v195, v190, v192
    v_fmac_f32 v193, v195, v195
    v_sub_f32 v195, v191, v192
    v_fmac_f32 v193, v195, v195
    s_nop 1
    v_add_f32_dpp v193, v193, v193 quad_perm:[1,0,3,2] row_mask:0xf bank_mask:0xf
    s_nop 1
    v_add_f32_dpp v193, v193, v193 quad_perm:[2,3,0,1] row_mask:0xf bank_mask:0xf
    s_nop 1
    v_add_f32_dpp v193, v193, v193 row_half_mirror row_mask:0xf bank_mask:0xf
    s_nop 1
    v_add_f32_dpp v193, v193, v193 row_mirror row_mask:0xf bank_mask:0xf
    v_mov_b32 v194, v193
    s_nop 1
    v_permlane16_swap_b32 v193, v194
    s_nop 1
    v_add_f32 v193, v193, v194
    v_mov_b32 v194, v193
    s_nop 1
    v_permlane32_swap_b32 v193, v194
    s_nop 1
    v_add_f32 v193, v193, v194
    v_mul_f32 v193, 0x3a800000, v193
    v_cvt_pk_bf16_f32 v194, v192, v193
    v_lshlrev_b32 v192, 16, v194
    v_and_b32 v193, 0xffff0000, v194
    v_add_f32 v193, 0x3727c5ac, v193
    v_cvt_pk_bf16_f32 v194, v193, v193
    v_lshlrev_b32 v193, 16, v194
    v_sqrt_f32 v193, v193
    s_nop 0
    v_cvt_pk_bf16_f32 v194, v193, v193
    v_lshlrev_b32 v193, 16, v194
    v_rcp_f32 v193, v193
    s_nop 0
    v_sub_f32 v176, v176, v192
    v_sub_f32 v177, v177, v192
    v_cvt_pk_bf16_f32 v194, v176, v177
    v_lshlrev_b32 v195, 16, v194
    v_and_b32 v196, 0xffff0000, v194
    v_mul_f32 v195, v195, v193
    v_mul_f32 v196, v196, v193
    v_cvt_pk_bf16_f32 v128, v195, v196
    v_sub_f32 v178, v178, v192
    v_sub_f32 v179, v179, v192
    v_cvt_pk_bf16_f32 v194, v178, v179
    v_lshlrev_b32 v195, 16, v194
    v_and_b32 v196, 0xffff0000, v194
    v_mul_f32 v195, v195, v193
    v_mul_f32 v196, v196, v193
    v_cvt_pk_bf16_f32 v129, v195, v196
    v_sub_f32 v180, v180, v192
    v_sub_f32 v181, v181, v192
    v_cvt_pk_bf16_f32 v194, v180, v181
    v_lshlrev_b32 v195, 16, v194
    v_and_b32 v196, 0xffff0000, v194
    v_mul_f32 v195, v195, v193
    v_mul_f32 v196, v196, v193
    v_cvt_pk_bf16_f32 v130, v195, v196
    v_sub_f32 v182, v182, v192
    v_sub_f32 v183, v183, v192
    v_cvt_pk_bf16_f32 v194, v182, v183
    v_lshlrev_b32 v195, 16, v194
    v_and_b32 v196, 0xffff0000, v194
    v_mul_f32 v195, v195, v193
    v_mul_f32 v196, v196, v193
    v_cvt_pk_bf16_f32 v131, v195, v196
    v_sub_f32 v184, v184, v192
    v_sub_f32 v185, v185, v192
    v_cvt_pk_bf16_f32 v194, v184, v185
    v_lshlrev_b32 v195, 16, v194
    v_and_b32 v196, 0xffff0000, v194
    v_mul_f32 v195, v195, v193
    v_mul_f32 v196, v196, v193
    v_cvt_pk_bf16_f32 v132, v195, v196
    v_sub_f32 v186, v186, v192
    v_sub_f32 v187, v187, v192
    v_cvt_pk_bf16_f32 v194, v186, v187
    v_lshlrev_b32 v195, 16, v194
    v_and_b32 v196, 0xffff0000, v194
    v_mul_f32 v195, v195, v193
    v_mul_f32 v196, v196, v193
    v_cvt_pk_bf16_f32 v133, v195, v196
    v_sub_f32 v188, v188, v192
    v_sub_f32 v189, v189, v192
    v_cvt_pk_bf16_f32 v194, v188, v189
    v_lshlrev_b32 v195, 16, v194
    v_and_b32 v196, 0xffff0000, v194
    v_mul_f32 v195, v195, v193
    v_mul_f32 v196, v196, v193
    v_cvt_pk_bf16_f32 v134, v195, v196
    v_sub_f32 v190, v190, v192
    v_sub_f32 v191, v191, v192
    v_cvt_pk_bf16_f32 v194, v190, v191
    v_lshlrev_b32 v195, 16, v194
    v_and_b32 v196, 0xffff0000, v194
    v_mul_f32 v195, v195, v193
    v_mul_f32 v196, v196, v193
    v_cvt_pk_bf16_f32 v135, v195, v196
    buffer_store_dwordx4 v[128:131], v10, s[8:11], 0 offen offset:0 sc1
    buffer_store_dwordx4 v[132:135], v10, s[8:11], 0 offen offset:1024 sc1
    s_waitcnt vmcnt(0)
    s_barrier
    s_cmp_lg_u32 s20, 0
    s_cbranch_scc1 g1_lnwait
    v_mov_b32 v28, 1
    s_mov_b64 exec, 1
    buffer_atomic_add v28, v11, s[52:55], 0 offen sc1
    s_mov_b64 exec, -1
g1_lnwait:
    s_lshl_b32 s28, s2, 3
    s_add_u32 s28, s28, s20
    s_lshl_b32 s28, s28, 12
    v_lshl_add_u32 v31, v1, 6, s28
    s_mov_b32 s40, s6
    s_mov_b32 s41, s7
    s_and_b32 s41, s41, 0xffff
    s_mov_b32 s42, 0x600000
    s_mov_b32 s43, 0x00020000
    buffer_load_dword v30, v31, s[40:43], 0 offen
    s_mov_b32 s40, s30
    s_mov_b32 s41, s31
    s_and_b32 s41, s41, 0xffff
    s_mov_b32 s42, 0x700000
    s_mov_b32 s43, 0x00020000
    buffer_load_dword v30, v31, s[40:43], 0 offen
    s_cmp_ge_u32 s2, 8
    s_cbranch_scc1 g1_nz
    s_add_u32 s40, s4, 0x3800000
    s_addc_u32 s41, s5, 0
    s_and_b32 s41, s41, 0xffff
    s_mov_b32 s42, 0x10000
    s_mov_b32 s43, 0x00020000
    s_lshl_b32 s28, s2, 13
    v_lshl_add_u32 v28, v0, 4, s28
    v_mov_b32 v24, 0
    v_mov_b32 v25, 0
    v_mov_b32 v26, 0
    v_mov_b32 v27, 0
    buffer_store_dwordx4 v[24:27], v28, s[40:43], 0 offen
    s_nop 1
g1_nz:
    s_mov_b32 s16, 0
    s_mov_b32 s17, 0
    s_cmp_ge_u32 s24, 4
    s_cbranch_scc1 g1_w1
    s_mul_i32 s28, s22, 6
    s_add_u32 s28, s28, 0
    v_xor_b32 v7, s28, v6
    v_lshl_add_u32 v18, v7, 5, v5
    s_mul_i32 s28, s22, 6
    s_add_u32 s28, s28, 1
    v_xor_b32 v7, s28, v6
    v_lshl_add_u32 v19, v7, 5, v5
    s_mul_i32 s28, s22, 6
    s_add_u32 s28, s28, 2
    v_xor_b32 v7, s28, v6
    v_lshl_add_u32 v20, v7, 5, v5
    s_mul_i32 s28, s22, 6
    s_add_u32 s28, s28, 3
    v_xor_b32 v7, s28, v6
    v_lshl_add_u32 v21, v7, 5, v5
    s_mul_i32 s28, s22, 6
    s_add_u32 s28, s28, 4
    v_xor_b32 v7, s28, v6
    v_lshl_add_u32 v22, v7, 5, v5
    s_mul_i32 s28, s22, 6
    s_add_u32 s28, s28, 5
    v_xor_b32 v7, s28, v6
    v_lshl_add_u32 v23, v7, 5, v5
    s_mov_b32 s12, s6
    s_mov_b32 s13, s7
    s_and_b32 s13, s13, 0xffff
    s_mov_b32 s14, 0x600000
    s_mov_b32 s15, 0x00020000
    v_lshrrev_b32 v25, 5, v1
    v_add_u32 v25, 0, v25
    s_bfe_u32 s28, s20, 0x10001
    s_lshl_b32 s28, s28, 2
    v_or_b32 v26, s28, v25
    v_lshlrev_b32 v26, 1, v26
    v_and_b32 v27, 31, v1
    v_xor_b32 v26, v26, v27
    s_lshl_b32 s28, s20, 2
    v_add_u32 v25, s28, v25
    v_lshrrev_b32 v27, 2, v26
    v_cmp_le_u32 vcc, 3, v27
    s_nop 1
    v_cndmask_b32 v28, 0, 1, vcc
    v_mul_u32_u24 v29, 3, v28
    v_sub_u32 v29, v27, v29
    s_lshl_b32 s28, s25, 1
    v_add_u32 v28, s28, v28
    v_lshlrev_b32 v28, 6, v28
    v_lshl_add_u32 v28, v29, 11, v28
    v_and_b32 v29, 3, v26
    v_lshl_add_u32 v28, v29, 4, v28
    s_movk_i32 s28, 6144
    v_mul_lo_u32 v29, v25, s28
    v_add_u32 v28, v28, v29
    v_cmp_gt_u32 vcc, 6, v27
    v_mov_b32 v29, 0x7f000000
    s_nop 0
    v_cndmask_b32 v12, v29, v28, vcc
    v_lshrrev_b32 v25, 5, v1
    v_add_u32 v25, 2, v25
    s_bfe_u32 s28, s20, 0x10001
    s_lshl_b32 s28, s28, 2
    v_or_b32 v26, s28, v25
    v_lshlrev_b32 v26, 1, v26
    v_and_b32 v27, 31, v1
    v_xor_b32 v26, v26, v27
    s_lshl_b32 s28, s20, 2
    v_add_u32 v25, s28, v25
    v_lshrrev_b32 v27, 2, v26
    v_cmp_le_u32 vcc, 3, v27
    s_nop 1
    v_cndmask_b32 v28, 0, 1, vcc
    v_mul_u32_u24 v29, 3, v28
    v_sub_u32 v29, v27, v29
    s_lshl_b32 s28, s25, 1
    v_add_u32 v28, s28, v28
    v_lshlrev_b32 v28, 6, v28
    v_lshl_add_u32 v28, v29, 11, v28
    v_and_b32 v29, 3, v26
    v_lshl_add_u32 v28, v29, 4, v28
    s_movk_i32 s28, 6144
    v_mul_lo_u32 v29, v25, s28
    v_add_u32 v28, v28, v29
    v_cmp_gt_u32 vcc, 6, v27
    v_mov_b32 v29, 0x7f000000
    s_nop 0
    v_cndmask_b32 v13, v29, v28, vcc
    s_add_u32 m0, s27, 65536
    s_nop 0
    buffer_load_dwordx4 v12, s[12:15], s17 offen lds
    s_add_u32 m0, s27, 66560
    s_nop 0
    buffer_load_dwordx4 v13, s[12:15], s17 offen lds
    s_add_u32 s17, s17, 196608
    s_add_u32 m0, s27, 81920
    s_nop 0
    buffer_load_dwordx4 v12, s[12:15], s17 offen lds
    s_add_u32 m0, s27, 82944
    s_nop 0
    buffer_load_dwordx4 v13, s[12:15], s17 offen lds
    s_add_u32 s17, s17, 196608
    s_add_u32 m0, s27, 98304
    s_nop 0
    buffer_load_dwordx4 v12, s[12:15], s17 offen lds
    s_add_u32 m0, s27, 99328
    s_nop 0
    buffer_load_dwordx4 v13, s[12:15], s17 offen lds
    s_add_u32 s17, s17, 196608
    s_add_u32 m0, s27, 114688
    s_nop 0
    buffer_load_dwordx4 v12, s[12:15], s17 offen lds
    s_add_u32 m0, s27, 115712
    s_nop 0
    buffer_load_dwordx4 v13, s[12:15], s17 offen lds
    s_add_u32 s17, s17, 196608
    s_cmp_lg_u32 s20, 0
    s_cbranch_scc1 g1q_lnbar
    s_mov_b32 s29, 0
g1q_lnspin:
    buffer_load_dword v28, v11, s[52:55], 0 offen sc1
    s_waitcnt vmcnt(0)
    v_readfirstlane_b32 s28, v28
    s_add_u32 s29, s29, 1
    s_cmp_ge_u32 s28, 32
    s_cbranch_scc1 g1q_lnbar
    s_sleep 4
    s_cmp_lt_u32 s29, 0x100000
    s_cbranch_scc1 g1q_lnspin
g1q_lnbar:
    s_barrier
    s_add_u32 m0, s27, 0
    s_nop 0
    buffer_load_dwordx4 v8, s[8:11], s16 offen sc1 lds
    s_add_u32 m0, s27, 1024
    s_nop 0
    buffer_load_dwordx4 v9, s[8:11], s16 offen sc1 lds
    s_add_u32 s16, s16, 64
    s_add_u32 m0, s27, 16384
    s_nop 0
    buffer_load_dwordx4 v8, s[8:11], s16 offen sc1 lds
    s_add_u32 m0, s27, 17408
    s_nop 0
    buffer_load_dwordx4 v9, s[8:11], s16 offen sc1 lds
    s_add_u32 s16, s16, 64
    s_add_u32 m0, s27, 32768
    s_nop 0
    buffer_load_dwordx4 v8, s[8:11], s16 offen sc1 lds
    s_add_u32 m0, s27, 33792
    s_nop 0
    buffer_load_dwordx4 v9, s[8:11], s16 offen sc1 lds
    s_add_u32 s16, s16, 64
    s_add_u32 m0, s27, 49152
    s_nop 0
    buffer_load_dwordx4 v8, s[8:11], s16 offen sc1 lds
    s_add_u32 m0, s27, 50176
    s_nop 0
    buffer_load_dwordx4 v9, s[8:11], s16 offen sc1 lds
    s_add_u32 s16, s16, 64
    v_mov_b32 v128, 0
    v_mov_b32 v129, 0
    v_mov_b32 v130, 0
    v_mov_b32 v131, 0
    v_mov_b32 v132, 0
    v_mov_b32 v133, 0
    v_mov_b32 v134, 0
    v_mov_b32 v135, 0
    v_mov_b32 v136, 0
    v_mov_b32 v137, 0
    v_mov_b32 v138, 0
    v_mov_b32 v139, 0
    v_mov_b32 v140, 0
    v_mov_b32 v141, 0
    v_mov_b32 v142, 0
    v_mov_b32 v143, 0
    v_mov_b32 v144, 0
    v_mov_b32 v145, 0
    v_mov_b32 v146, 0
    v_mov_b32 v147, 0
    v_mov_b32 v148, 0
    v_mov_b32 v149, 0
    v_mov_b32 v150, 0
    v_mov_b32 v151, 0
    v_mov_b32 v152, 0
    v_mov_b32 v153, 0
    v_mov_b32 v154, 0
    v_mov_b32 v155, 0
    v_mov_b32 v156, 0
    v_mov_b32 v157, 0
    v_mov_b32 v158, 0
    v_mov_b32 v159, 0
    v_mov_b32 v160, 0
    v_mov_b32 v161, 0
    v_mov_b32 v162, 0
    v_mov_b32 v163, 0
    v_mov_b32 v164, 0
    v_mov_b32 v165, 0
    v_mov_b32 v166, 0
    v_mov_b32 v167, 0
    v_mov_b32 v168, 0
    v_mov_b32 v169, 0
    v_mov_b32 v170, 0
    v_mov_b32 v171, 0
    v_mov_b32 v172, 0
    v_mov_b32 v173, 0
    v_mov_b32 v174, 0
    v_mov_b32 v175, 0
    v_mov_b32 v176, 0
    v_mov_b32 v177, 0
    v_mov_b32 v178, 0
    v_mov_b32 v179, 0
    v_mov_b32 v180, 0
    v_mov_b32 v181, 0
    v_mov_b32 v182, 0
    v_mov_b32 v183, 0
    v_mov_b32 v184, 0
    v_mov_b32 v185, 0
    v_mov_b32 v186, 0
    v_mov_b32 v187, 0
    v_mov_b32 v188, 0
    v_mov_b32 v189, 0
    v_mov_b32 v190, 0
    v_mov_b32 v191, 0
    v_mov_b32 v192, 0
    v_mov_b32 v193, 0
    v_mov_b32 v194, 0
    v_mov_b32 v195, 0
    v_mov_b32 v196, 0
    v_mov_b32 v197, 0
    v_mov_b32 v198, 0
    v_mov_b32 v199, 0
    v_mov_b32 v200, 0
    v_mov_b32 v201, 0
    v_mov_b32 v202, 0
    v_mov_b32 v203, 0
    v_mov_b32 v204, 0
    v_mov_b32 v205, 0
    v_mov_b32 v206, 0
    v_mov_b32 v207, 0
    v_mov_b32 v208, 0
    v_mov_b32 v209, 0
    v_mov_b32 v210, 0
    v_mov_b32 v211, 0
    v_mov_b32 v212, 0
    v_mov_b32 v213, 0
    v_mov_b32 v214, 0
    v_mov_b32 v215, 0
    v_mov_b32 v216, 0
    v_mov_b32 v217, 0
    v_mov_b32 v218, 0
    v_mov_b32 v219, 0
    v_mov_b32 v220, 0
    v_mov_b32 v221, 0
    v_mov_b32 v222, 0
    v_mov_b32 v223, 0
    s_waitcnt vmcnt(0)
    s_barrier
    ds_read_b128 v[32:35], v16 offset:0
    ds_read_b128 v[36:39], v16 offset:1024
    ds_read_b128 v[40:43], v16 offset:2048
    ds_read_b128 v[44:47], v16 offset:3072
    ds_read_b64_tr_b16 v[48:49], v18 offset:0
    ds_read_b64_tr_b16 v[50:51], v18 offset:2048
    ds_read_b64_tr_b16 v[52:53], v19 offset:0
    ds_read_b64_tr_b16 v[54:55], v19 offset:2048
    ds_read_b64_tr_b16 v[56:57], v20 offset:0
    ds_read_b64_tr_b16 v[58:59], v20 offset:2048
    ds_read_b64_tr_b16 v[60:61], v21 offset:0
    ds_read_b64_tr_b16 v[62:63], v21 offset:2048
    ds_read_b64_tr_b16 v[64:65], v22 offset:0
    ds_read_b64_tr_b16 v[66:67], v22 offset:2048
    ds_read_b64_tr_b16 v[68:69], v23 offset:0
    ds_read_b64_tr_b16 v[70:71], v23 offset:2048
    s_waitcnt lgkmcnt(0)
    s_barrier
    s_mov_b32 s18, 7
g1q_loop:
    v_mfma_f32_16x16x32_bf16 v[128:131], v[48:51], v[32:35], v[128:131]
    ds_read_b128 v[76:79], v16 offset:16384
    v_mfma_f32_16x16x32_bf16 v[132:135], v[52:55], v[32:35], v[132:135]
    s_add_u32 m0, s27, 0
    s_nop 0
    buffer_load_dwordx4 v8, s[8:11], s16 offen sc1 lds
    v_mfma_f32_16x16x32_bf16 v[136:139], v[56:59], v[32:35], v[136:139]
    ds_read_b128 v[80:83], v16 offset:17408
    v_mfma_f32_16x16x32_bf16 v[140:143], v[60:63], v[32:35], v[140:143]
    ds_read_b128 v[84:87], v16 offset:18432
    v_mfma_f32_16x16x32_bf16 v[144:147], v[32:35], v[64:67], v[144:147]
    ds_read_b128 v[88:91], v16 offset:19456
    v_mfma_f32_16x16x32_bf16 v[148:151], v[32:35], v[68:71], v[148:151]
    ds_read_b64_tr_b16 v[92:93], v18 offset:16384
    v_mfma_f32_16x16x32_bf16 v[152:155], v[48:51], v[36:39], v[152:155]
    s_add_u32 m0, s27, 1024
    s_nop 0
    buffer_load_dwordx4 v9, s[8:11], s16 offen sc1 lds
    v_mfma_f32_16x16x32_bf16 v[156:159], v[52:55], v[36:39], v[156:159]
    ds_read_b64_tr_b16 v[94:95], v18 offset:18432
    v_mfma_f32_16x16x32_bf16 v[160:163], v[56:59], v[36:39], v[160:163]
    ds_read_b64_tr_b16 v[96:97], v19 offset:16384
    v_mfma_f32_16x16x32_bf16 v[164:167], v[60:63], v[36:39], v[164:167]
    ds_read_b64_tr_b16 v[98:99], v19 offset:18432
    v_mfma_f32_16x16x32_bf16 v[168:171], v[36:39], v[64:67], v[168:171]
    ds_read_b64_tr_b16 v[100:101], v20 offset:16384
    v_mfma_f32_16x16x32_bf16 v[172:175], v[36:39], v[68:71], v[172:175]
    ds_read_b64_tr_b16 v[102:103], v20 offset:18432
    v_mfma_f32_16x16x32_bf16 v[176:179], v[48:51], v[40:43], v[176:179]
    s_add_u32 m0, s27, 65536
    s_nop 0
    buffer_load_dwordx4 v12, s[12:15], s17 offen lds
    v_mfma_f32_16x16x32_bf16 v[180:183], v[52:55], v[40:43], v[180:183]
    ds_read_b64_tr_b16 v[104:105], v21 offset:16384
    v_mfma_f32_16x16x32_bf16 v[184:187], v[56:59], v[40:43], v[184:187]
    ds_read_b64_tr_b16 v[106:107], v21 offset:18432
    v_mfma_f32_16x16x32_bf16 v[188:191], v[60:63], v[40:43], v[188:191]
    ds_read_b64_tr_b16 v[108:109], v22 offset:16384
    v_mfma_f32_16x16x32_bf16 v[192:195], v[40:43], v[64:67], v[192:195]
    ds_read_b64_tr_b16 v[110:111], v22 offset:18432
    v_mfma_f32_16x16x32_bf16 v[196:199], v[40:43], v[68:71], v[196:199]
    s_add_u32 m0, s27, 66560
    s_nop 0
    buffer_load_dwordx4 v13, s[12:15], s17 offen lds
    s_add_u32 s16, s16, 64
    s_add_u32 s17, s17, 196608
    v_mfma_f32_16x16x32_bf16 v[200:203], v[48:51], v[44:47], v[200:203]
    ds_read_b64_tr_b16 v[112:113], v23 offset:16384
    v_mfma_f32_16x16x32_bf16 v[204:207], v[52:55], v[44:47], v[204:207]
    ds_read_b64_tr_b16 v[114:115], v23 offset:18432
    v_mfma_f32_16x16x32_bf16 v[208:211], v[56:59], v[44:47], v[208:211]
    v_mfma_f32_16x16x32_bf16 v[212:215], v[60:63], v[44:47], v[212:215]
    v_mfma_f32_16x16x32_bf16 v[216:219], v[44:47], v[64:67], v[216:219]
    v_mfma_f32_16x16x32_bf16 v[220:223], v[44:47], v[68:71], v[220:223]
    s_waitcnt vmcnt(8) lgkmcnt(0)
    s_barrier
    v_mfma_f32_16x16x32_bf16 v[128:131], v[92:95], v[76:79], v[128:131]
    ds_read_b128 v[32:35], v16 offset:32768
    v_mfma_f32_16x16x32_bf16 v[132:135], v[96:99], v[76:79], v[132:135]
    s_add_u32 m0, s27, 16384
    s_nop 0
    buffer_load_dwordx4 v8, s[8:11], s16 offen sc1 lds
    v_mfma_f32_16x16x32_bf16 v[136:139], v[100:103], v[76:79], v[136:139]
    ds_read_b128 v[36:39], v16 offset:33792
    v_mfma_f32_16x16x32_bf16 v[140:143], v[104:107], v[76:79], v[140:143]
    ds_read_b128 v[40:43], v16 offset:34816
    v_mfma_f32_16x16x32_bf16 v[144:147], v[76:79], v[108:111], v[144:147]
    ds_read_b128 v[44:47], v16 offset:35840
    v_mfma_f32_16x16x32_bf16 v[148:151], v[76:79], v[112:115], v[148:151]
    ds_read_b64_tr_b16 v[48:49], v18 offset:32768
    v_mfma_f32_16x16x32_bf16 v[152:155], v[92:95], v[80:83], v[152:155]
    s_add_u32 m0, s27, 17408
    s_nop 0
    buffer_load_dwordx4 v9, s[8:11], s16 offen sc1 lds
    v_mfma_f32_16x16x32_bf16 v[156:159], v[96:99], v[80:83], v[156:159]
    ds_read_b64_tr_b16 v[50:51], v18 offset:34816
    v_mfma_f32_16x16x32_bf16 v[160:163], v[100:103], v[80:83], v[160:163]
    ds_read_b64_tr_b16 v[52:53], v19 offset:32768
    v_mfma_f32_16x16x32_bf16 v[164:167], v[104:107], v[80:83], v[164:167]
    ds_read_b64_tr_b16 v[54:55], v19 offset:34816
    v_mfma_f32_16x16x32_bf16 v[168:171], v[80:83], v[108:111], v[168:171]
    ds_read_b64_tr_b16 v[56:57], v20 offset:32768
    v_mfma_f32_16x16x32_bf16 v[172:175], v[80:83], v[112:115], v[172:175]
    ds_read_b64_tr_b16 v[58:59], v20 offset:34816
    v_mfma_f32_16x16x32_bf16 v[176:179], v[92:95], v[84:87], v[176:179]
    s_add_u32 m0, s27, 81920
    s_nop 0
    buffer_load_dwordx4 v12, s[12:15], s17 offen lds
    v_mfma_f32_16x16x32_bf16 v[180:183], v[96:99], v[84:87], v[180:183]
    ds_read_b64_tr_b16 v[60:61], v21 offset:32768
    v_mfma_f32_16x16x32_bf16 v[184:187], v[100:103], v[84:87], v[184:187]
    ds_read_b64_tr_b16 v[62:63], v21 offset:34816
    v_mfma_f32_16x16x32_bf16 v[188:191], v[104:107], v[84:87], v[188:191]
    ds_read_b64_tr_b16 v[64:65], v22 offset:32768
    v_mfma_f32_16x16x32_bf16 v[192:195], v[84:87], v[108:111], v[192:195]
    ds_read_b64_tr_b16 v[66:67], v22 offset:34816
    v_mfma_f32_16x16x32_bf16 v[196:199], v[84:87], v[112:115], v[196:199]
    s_add_u32 m0, s27, 82944
    s_nop 0
    buffer_load_dwordx4 v13, s[12:15], s17 offen lds
    s_add_u32 s16, s16, 64
    s_add_u32 s17, s17, 196608
    v_mfma_f32_16x16x32_bf16 v[200:203], v[92:95], v[88:91], v[200:203]
    ds_read_b64_tr_b16 v[68:69], v23 offset:32768
    v_mfma_f32_16x16x32_bf16 v[204:207], v[96:99], v[88:91], v[204:207]
    ds_read_b64_tr_b16 v[70:71], v23 offset:34816
    v_mfma_f32_16x16x32_bf16 v[208:211], v[100:103], v[88:91], v[208:211]
    v_mfma_f32_16x16x32_bf16 v[212:215], v[104:107], v[88:91], v[212:215]
    v_mfma_f32_16x16x32_bf16 v[216:219], v[88:91], v[108:111], v[216:219]
    v_mfma_f32_16x16x32_bf16 v[220:223], v[88:91], v[112:115], v[220:223]
    s_waitcnt vmcnt(8) lgkmcnt(0)
    s_barrier
    v_mfma_f32_16x16x32_bf16 v[128:131], v[48:51], v[32:35], v[128:131]
    ds_read_b128 v[76:79], v16 offset:49152
    v_mfma_f32_16x16x32_bf16 v[132:135], v[52:55], v[32:35], v[132:135]
    s_add_u32 m0, s27, 32768
    s_nop 0
    buffer_load_dwordx4 v8, s[8:11], s16 offen sc1 lds
    v_mfma_f32_16x16x32_bf16 v[136:139], v[56:59], v[32:35], v[136:139]
    ds_read_b128 v[80:83], v16 offset:50176
    v_mfma_f32_16x16x32_bf16 v[140:143], v[60:63], v[32:35], v[140:143]
    ds_read_b128 v[84:87], v16 offset:51200
    v_mfma_f32_16x16x32_bf16 v[144:147], v[32:35], v[64:67], v[144:147]
    ds_read_b128 v[88:91], v16 offset:52224
    v_mfma_f32_16x16x32_bf16 v[148:151], v[32:35], v[68:71], v[148:151]
    ds_read_b64_tr_b16 v[92:93], v18 offset:49152
    v_mfma_f32_16x16x32_bf16 v[152:155], v[48:51], v[36:39], v[152:155]
    s_add_u32 m0, s27, 33792
    s_nop 0
    buffer_load_dwordx4 v9, s[8:11], s16 offen sc1 lds
    v_mfma_f32_16x16x32_bf16 v[156:159], v[52:55], v[36:39], v[156:159]
    ds_read_b64_tr_b16 v[94:95], v18 offset:51200
    v_mfma_f32_16x16x32_bf16 v[160:163], v[56:59], v[36:39], v[160:163]
    ds_read_b64_tr_b16 v[96:97], v19 offset:49152
    v_mfma_f32_16x16x32_bf16 v[164:167], v[60:63], v[36:39], v[164:167]
    ds_read_b64_tr_b16 v[98:99], v19 offset:51200
    v_mfma_f32_16x16x32_bf16 v[168:171], v[36:39], v[64:67], v[168:171]
    ds_read_b64_tr_b16 v[100:101], v20 offset:49152
    v_mfma_f32_16x16x32_bf16 v[172:175], v[36:39], v[68:71], v[172:175]
    ds_read_b64_tr_b16 v[102:103], v20 offset:51200
    v_mfma_f32_16x16x32_bf16 v[176:179], v[48:51], v[40:43], v[176:179]
    s_add_u32 m0, s27, 98304
    s_nop 0
    buffer_load_dwordx4 v12, s[12:15], s17 offen lds
    v_mfma_f32_16x16x32_bf16 v[180:183], v[52:55], v[40:43], v[180:183]
    ds_read_b64_tr_b16 v[104:105], v21 offset:49152
    v_mfma_f32_16x16x32_bf16 v[184:187], v[56:59], v[40:43], v[184:187]
    ds_read_b64_tr_b16 v[106:107], v21 offset:51200
    v_mfma_f32_16x16x32_bf16 v[188:191], v[60:63], v[40:43], v[188:191]
    ds_read_b64_tr_b16 v[108:109], v22 offset:49152
    v_mfma_f32_16x16x32_bf16 v[192:195], v[40:43], v[64:67], v[192:195]
    ds_read_b64_tr_b16 v[110:111], v22 offset:51200
    v_mfma_f32_16x16x32_bf16 v[196:199], v[40:43], v[68:71], v[196:199]
    s_add_u32 m0, s27, 99328
    s_nop 0
    buffer_load_dwordx4 v13, s[12:15], s17 offen lds
    s_add_u32 s16, s16, 64
    s_add_u32 s17, s17, 196608
    v_mfma_f32_16x16x32_bf16 v[200:203], v[48:51], v[44:47], v[200:203]
    ds_read_b64_tr_b16 v[112:113], v23 offset:49152
    v_mfma_f32_16x16x32_bf16 v[204:207], v[52:55], v[44:47], v[204:207]
    ds_read_b64_tr_b16 v[114:115], v23 offset:51200
    v_mfma_f32_16x16x32_bf16 v[208:211], v[56:59], v[44:47], v[208:211]
    v_mfma_f32_16x16x32_bf16 v[212:215], v[60:63], v[44:47], v[212:215]
    v_mfma_f32_16x16x32_bf16 v[216:219], v[44:47], v[64:67], v[216:219]
    v_mfma_f32_16x16x32_bf16 v[220:223], v[44:47], v[68:71], v[220:223]
    s_waitcnt vmcnt(8) lgkmcnt(0)
    s_barrier
    v_mfma_f32_16x16x32_bf16 v[128:131], v[92:95], v[76:79], v[128:131]
    ds_read_b128 v[32:35], v16 offset:0
    v_mfma_f32_16x16x32_bf16 v[132:135], v[96:99], v[76:79], v[132:135]
    s_add_u32 m0, s27, 49152
    s_nop 0
    buffer_load_dwordx4 v8, s[8:11], s16 offen sc1 lds
    v_mfma_f32_16x16x32_bf16 v[136:139], v[100:103], v[76:79], v[136:139]
    ds_read_b128 v[36:39], v16 offset:1024
    v_mfma_f32_16x16x32_bf16 v[140:143], v[104:107], v[76:79], v[140:143]
    ds_read_b128 v[40:43], v16 offset:2048
    v_mfma_f32_16x16x32_bf16 v[144:147], v[76:79], v[108:111], v[144:147]
    ds_read_b128 v[44:47], v16 offset:3072
    v_mfma_f32_16x16x32_bf16 v[148:151], v[76:79], v[112:115], v[148:151]
    ds_read_b64_tr_b16 v[48:49], v18 offset:0
    v_mfma_f32_16x16x32_bf16 v[152:155], v[92:95], v[80:83], v[152:155]
    s_add_u32 m0, s27, 50176
    s_nop 0
    buffer_load_dwordx4 v9, s[8:11], s16 offen sc1 lds
    v_mfma_f32_16x16x32_bf16 v[156:159], v[96:99], v[80:83], v[156:159]
    ds_read_b64_tr_b16 v[50:51], v18 offset:2048
    v_mfma_f32_16x16x32_bf16 v[160:163], v[100:103], v[80:83], v[160:163]
    ds_read_b64_tr_b16 v[52:53], v19 offset:0
    v_mfma_f32_16x16x32_bf16 v[164:167], v[104:107], v[80:83], v[164:167]
    ds_read_b64_tr_b16 v[54:55], v19 offset:2048
    v_mfma_f32_16x16x32_bf16 v[168:171], v[80:83], v[108:111], v[168:171]
    ds_read_b64_tr_b16 v[56:57], v20 offset:0
    v_mfma_f32_16x16x32_bf16 v[172:175], v[80:83], v[112:115], v[172:175]
    ds_read_b64_tr_b16 v[58:59], v20 offset:2048
    v_mfma_f32_16x16x32_bf16 v[176:179], v[92:95], v[84:87], v[176:179]
    s_add_u32 m0, s27, 114688
    s_nop 0
    buffer_load_dwordx4 v12, s[12:15], s17 offen lds
    v_mfma_f32_16x16x32_bf16 v[180:183], v[96:99], v[84:87], v[180:183]
    ds_read_b64_tr_b16 v[60:61], v21 offset:0
    v_mfma_f32_16x16x32_bf16 v[184:187], v[100:103], v[84:87], v[184:187]
    ds_read_b64_tr_b16 v[62:63], v21 offset:2048
    v_mfma_f32_16x16x32_bf16 v[188:191], v[104:107], v[84:87], v[188:191]
    ds_read_b64_tr_b16 v[64:65], v22 offset:0
    v_mfma_f32_16x16x32_bf16 v[192:195], v[84:87], v[108:111], v[192:195]
    ds_read_b64_tr_b16 v[66:67], v22 offset:2048
    v_mfma_f32_16x16x32_bf16 v[196:199], v[84:87], v[112:115], v[196:199]
    s_add_u32 m0, s27, 115712
    s_nop 0
    buffer_load_dwordx4 v13, s[12:15], s17 offen lds
    s_add_u32 s16, s16, 64
    s_add_u32 s17, s17, 196608
    v_mfma_f32_16x16x32_bf16 v[200:203], v[92:95], v[88:91], v[200:203]
    ds_read_b64_tr_b16 v[68:69], v23 offset:0
    v_mfma_f32_16x16x32_bf16 v[204:207], v[96:99], v[88:91], v[204:207]
    ds_read_b64_tr_b16 v[70:71], v23 offset:2048
    v_mfma_f32_16x16x32_bf16 v[208:211], v[100:103], v[88:91], v[208:211]
    v_mfma_f32_16x16x32_bf16 v[212:215], v[104:107], v[88:91], v[212:215]
    v_mfma_f32_16x16x32_bf16 v[216:219], v[88:91], v[108:111], v[216:219]
    v_mfma_f32_16x16x32_bf16 v[220:223], v[88:91], v[112:115], v[220:223]
    s_waitcnt vmcnt(8) lgkmcnt(0)
    s_barrier
    s_sub_u32 s18, s18, 1
    s_cmp_lg_u32 s18, 0
    s_cbranch_scc1 g1q_loop
    s_mov_b32 s36, s32
    s_mov_b32 s37, s33
    s_and_b32 s37, s37, 0xffff
    s_mov_b32 s38, 0x10000
    s_mov_b32 s39, 0x00020000
    s_lshl_b32 s28, s25, 1
    s_add_u32 s28, s28, s22
    s_lshl_b32 s28, s28, 11
    v_lshlrev_b32 v25, 8, v4
    v_lshl_add_u32 v25, v3, 1, v25
    v_add_u32 v25, s28, v25
    buffer_load_ushort v224, v25, s[36:39], 0 offen offset:0
    buffer_load_ushort v225, v25, s[36:39], 0 offen offset:64
    buffer_load_ushort v226, v25, s[36:39], 0 offen offset:128
    buffer_load_ushort v227, v25, s[36:39], 0 offen offset:192
    buffer_load_ushort v228, v25, s[36:39], 0 offen offset:1024
    buffer_load_ushort v229, v25, s[36:39], 0 offen offset:1088
    buffer_load_ushort v230, v25, s[36:39], 0 offen offset:1152
    buffer_load_ushort v231, v25, s[36:39], 0 offen offset:1216
    buffer_load_ushort v232, v25, s[36:39], 0 offen offset:32
    buffer_load_ushort v233, v25, s[36:39], 0 offen offset:96
    buffer_load_ushort v234, v25, s[36:39], 0 offen offset:160
    buffer_load_ushort v235, v25, s[36:39], 0 offen offset:224
    buffer_load_ushort v236, v25, s[36:39], 0 offen offset:1056
    buffer_load_ushort v237, v25, s[36:39], 0 offen offset:1120
    buffer_load_ushort v238, v25, s[36:39], 0 offen offset:1184
    buffer_load_ushort v239, v25, s[36:39], 0 offen offset:1248
    v_mfma_f32_16x16x32_bf16 v[128:131], v[48:51], v[32:35], v[128:131]
    ds_read_b128 v[76:79], v16 offset:16384
    v_mfma_f32_16x16x32_bf16 v[132:135], v[52:55], v[32:35], v[132:135]
    v_mfma_f32_16x16x32_bf16 v[136:139], v[56:59], v[32:35], v[136:139]
    ds_read_b128 v[80:83], v16 offset:17408
    v_mfma_f32_16x16x32_bf16 v[140:143], v[60:63], v[32:35], v[140:143]
    ds_read_b128 v[84:87], v16 offset:18432
    v_mfma_f32_16x16x32_bf16 v[144:147], v[32:35], v[64:67], v[144:147]
    ds_read_b128 v[88:91], v16 offset:19456
    v_mfma_f32_16x16x32_bf16 v[148:151], v[32:35], v[68:71], v[148:151]
    ds_read_b64_tr_b16 v[92:93], v18 offset:16384
    v_mfma_f32_16x16x32_bf16 v[152:155], v[48:51], v[36:39], v[152:155]
    v_mfma_f32_16x16x32_bf16 v[156:159], v[52:55], v[36:39], v[156:159]
    ds_read_b64_tr_b16 v[94:95], v18 offset:18432
    v_mfma_f32_16x16x32_bf16 v[160:163], v[56:59], v[36:39], v[160:163]
    ds_read_b64_tr_b16 v[96:97], v19 offset:16384
    v_mfma_f32_16x16x32_bf16 v[164:167], v[60:63], v[36:39], v[164:167]
    ds_read_b64_tr_b16 v[98:99], v19 offset:18432
    v_mfma_f32_16x16x32_bf16 v[168:171], v[36:39], v[64:67], v[168:171]
    ds_read_b64_tr_b16 v[100:101], v20 offset:16384
    v_mfma_f32_16x16x32_bf16 v[172:175], v[36:39], v[68:71], v[172:175]
    ds_read_b64_tr_b16 v[102:103], v20 offset:18432
    v_mfma_f32_16x16x32_bf16 v[176:179], v[48:51], v[40:43], v[176:179]
    v_mfma_f32_16x16x32_bf16 v[180:183], v[52:55], v[40:43], v[180:183]
    ds_read_b64_tr_b16 v[104:105], v21 offset:16384
    v_mfma_f32_16x16x32_bf16 v[184:187], v[56:59], v[40:43], v[184:187]
    ds_read_b64_tr_b16 v[106:107], v21 offset:18432
    v_mfma_f32_16x16x32_bf16 v[188:191], v[60:63], v[40:43], v[188:191]
    ds_read_b64_tr_b16 v[108:109], v22 offset:16384
    v_mfma_f32_16x16x32_bf16 v[192:195], v[40:43], v[64:67], v[192:195]
    ds_read_b64_tr_b16 v[110:111], v22 offset:18432
    v_mfma_f32_16x16x32_bf16 v[196:199], v[40:43], v[68:71], v[196:199]
    v_mfma_f32_16x16x32_bf16 v[200:203], v[48:51], v[44:47], v[200:203]
    ds_read_b64_tr_b16 v[112:113], v23 offset:16384
    v_mfma_f32_16x16x32_bf16 v[204:207], v[52:55], v[44:47], v[204:207]
    ds_read_b64_tr_b16 v[114:115], v23 offset:18432
    v_mfma_f32_16x16x32_bf16 v[208:211], v[56:59], v[44:47], v[208:211]
    v_mfma_f32_16x16x32_bf16 v[212:215], v[60:63], v[44:47], v[212:215]
    v_mfma_f32_16x16x32_bf16 v[216:219], v[44:47], v[64:67], v[216:219]
    v_mfma_f32_16x16x32_bf16 v[220:223], v[44:47], v[68:71], v[220:223]
    s_waitcnt vmcnt(20) lgkmcnt(0)
    s_barrier
    v_mfma_f32_16x16x32_bf16 v[128:131], v[92:95], v[76:79], v[128:131]
    ds_read_b128 v[32:35], v16 offset:32768
    v_mfma_f32_16x16x32_bf16 v[132:135], v[96:99], v[76:79], v[132:135]
    v_mfma_f32_16x16x32_bf16 v[136:139], v[100:103], v[76:79], v[136:139]
    ds_read_b128 v[36:39], v16 offset:33792
    v_mfma_f32_16x16x32_bf16 v[140:143], v[104:107], v[76:79], v[140:143]
    ds_read_b128 v[40:43], v16 offset:34816
    v_mfma_f32_16x16x32_bf16 v[144:147], v[76:79], v[108:111], v[144:147]
    ds_read_b128 v[44:47], v16 offset:35840
    v_mfma_f32_16x16x32_bf16 v[148:151], v[76:79], v[112:115], v[148:151]
    ds_read_b64_tr_b16 v[48:49], v18 offset:32768
    v_mfma_f32_16x16x32_bf16 v[152:155], v[92:95], v[80:83], v[152:155]
    v_mfma_f32_16x16x32_bf16 v[156:159], v[96:99], v[80:83], v[156:159]
    ds_read_b64_tr_b16 v[50:51], v18 offset:34816
    v_mfma_f32_16x16x32_bf16 v[160:163], v[100:103], v[80:83], v[160:163]
    ds_read_b64_tr_b16 v[52:53], v19 offset:32768
    v_mfma_f32_16x16x32_bf16 v[164:167], v[104:107], v[80:83], v[164:167]
    ds_read_b64_tr_b16 v[54:55], v19 offset:34816
    v_mfma_f32_16x16x32_bf16 v[168:171], v[80:83], v[108:111], v[168:171]
    ds_read_b64_tr_b16 v[56:57], v20 offset:32768
    v_mfma_f32_16x16x32_bf16 v[172:175], v[80:83], v[112:115], v[172:175]
    ds_read_b64_tr_b16 v[58:59], v20 offset:34816
    v_mfma_f32_16x16x32_bf16 v[176:179], v[92:95], v[84:87], v[176:179]
    v_mfma_f32_16x16x32_bf16 v[180:183], v[96:99], v[84:87], v[180:183]
    ds_read_b64_tr_b16 v[60:61], v21 offset:32768
    v_mfma_f32_16x16x32_bf16 v[184:187], v[100:103], v[84:87], v[184:187]
    ds_read_b64_tr_b16 v[62:63], v21 offset:34816
    v_mfma_f32_16x16x32_bf16 v[188:191], v[104:107], v[84:87], v[188:191]
    ds_read_b64_tr_b16 v[64:65], v22 offset:32768
    v_mfma_f32_16x16x32_bf16 v[192:195], v[84:87], v[108:111], v[192:195]
    ds_read_b64_tr_b16 v[66:67], v22 offset:34816
    v_mfma_f32_16x16x32_bf16 v[196:199], v[84:87], v[112:115], v[196:199]
    v_mfma_f32_16x16x32_bf16 v[200:203], v[92:95], v[88:91], v[200:203]
    ds_read_b64_tr_b16 v[68:69], v23 offset:32768
    v_mfma_f32_16x16x32_bf16 v[204:207], v[96:99], v[88:91], v[204:207]
    ds_read_b64_tr_b16 v[70:71], v23 offset:34816
    v_mfma_f32_16x16x32_bf16 v[208:211], v[100:103], v[88:91], v[208:211]
    v_mfma_f32_16x16x32_bf16 v[212:215], v[104:107], v[88:91], v[212:215]
    v_mfma_f32_16x16x32_bf16 v[216:219], v[88:91], v[108:111], v[216:219]
    v_mfma_f32_16x16x32_bf16 v[220:223], v[88:91], v[112:115], v[220:223]
    s_waitcnt vmcnt(16) lgkmcnt(0)
    s_barrier
    v_mfma_f32_16x16x32_bf16 v[128:131], v[48:51], v[32:35], v[128:131]
    ds_read_b128 v[76:79], v16 offset:49152
    v_mfma_f32_16x16x32_bf16 v[132:135], v[52:55], v[32:35], v[132:135]
    v_mfma_f32_16x16x32_bf16 v[136:139], v[56:59], v[32:35], v[136:139]
    ds_read_b128 v[80:83], v16 offset:50176
    v_mfma_f32_16x16x32_bf16 v[140:143], v[60:63], v[32:35], v[140:143]
    ds_read_b128 v[84:87], v16 offset:51200
    v_mfma_f32_16x16x32_bf16 v[144:147], v[32:35], v[64:67], v[144:147]
    ds_read_b128 v[88:91], v16 offset:52224
    v_mfma_f32_16x16x32_bf16 v[148:151], v[32:35], v[68:71], v[148:151]
    ds_read_b64_tr_b16 v[92:93], v18 offset:49152
    v_mfma_f32_16x16x32_bf16 v[152:155], v[48:51], v[36:39], v[152:155]
    v_mfma_f32_16x16x32_bf16 v[156:159], v[52:55], v[36:39], v[156:159]
    ds_read_b64_tr_b16 v[94:95], v18 offset:51200
    v_mfma_f32_16x16x32_bf16 v[160:163], v[56:59], v[36:39], v[160:163]
    ds_read_b64_tr_b16 v[96:97], v19 offset:49152
    v_mfma_f32_16x16x32_bf16 v[164:167], v[60:63], v[36:39], v[164:167]
    ds_read_b64_tr_b16 v[98:99], v19 offset:51200
    v_mfma_f32_16x16x32_bf16 v[168:171], v[36:39], v[64:67], v[168:171]
    ds_read_b64_tr_b16 v[100:101], v20 offset:49152
    v_mfma_f32_16x16x32_bf16 v[172:175], v[36:39], v[68:71], v[172:175]
    ds_read_b64_tr_b16 v[102:103], v20 offset:51200
    v_mfma_f32_16x16x32_bf16 v[176:179], v[48:51], v[40:43], v[176:179]
    v_mfma_f32_16x16x32_bf16 v[180:183], v[52:55], v[40:43], v[180:183]
    ds_read_b64_tr_b16 v[104:105], v21 offset:49152
    v_mfma_f32_16x16x32_bf16 v[184:187], v[56:59], v[40:43], v[184:187]
    ds_read_b64_tr_b16 v[106:107], v21 offset:51200
    v_mfma_f32_16x16x32_bf16 v[188:191], v[60:63], v[40:43], v[188:191]
    ds_read_b64_tr_b16 v[108:109], v22 offset:49152
    v_mfma_f32_16x16x32_bf16 v[192:195], v[40:43], v[64:67], v[192:195]
    ds_read_b64_tr_b16 v[110:111], v22 offset:51200
    v_mfma_f32_16x16x32_bf16 v[196:199], v[40:43], v[68:71], v[196:199]
    v_mfma_f32_16x16x32_bf16 v[200:203], v[48:51], v[44:47], v[200:203]
    ds_read_b64_tr_b16 v[112:113], v23 offset:49152
    v_mfma_f32_16x16x32_bf16 v[204:207], v[52:55], v[44:47], v[204:207]
    ds_read_b64_tr_b16 v[114:115], v23 offset:51200
    v_mfma_f32_16x16x32_bf16 v[208:211], v[56:59], v[44:47], v[208:211]
    v_mfma_f32_16x16x32_bf16 v[212:215], v[60:63], v[44:47], v[212:215]
    v_mfma_f32_16x16x32_bf16 v[216:219], v[44:47], v[64:67], v[216:219]
    v_mfma_f32_16x16x32_bf16 v[220:223], v[44:47], v[68:71], v[220:223]
    s_waitcnt lgkmcnt(0)
    s_barrier
    v_mfma_f32_16x16x32_bf16 v[128:131], v[92:95], v[76:79], v[128:131]
    v_mfma_f32_16x16x32_bf16 v[132:135], v[96:99], v[76:79], v[132:135]
    v_mfma_f32_16x16x32_bf16 v[136:139], v[100:103], v[76:79], v[136:139]
    v_mfma_f32_16x16x32_bf16 v[140:143], v[104:107], v[76:79], v[140:143]
    v_mfma_f32_16x16x32_bf16 v[144:147], v[76:79], v[108:111], v[144:147]
    v_mfma_f32_16x16x32_bf16 v[148:151], v[76:79], v[112:115], v[148:151]
    v_mfma_f32_16x16x32_bf16 v[152:155], v[92:95], v[80:83], v[152:155]
    v_mfma_f32_16x16x32_bf16 v[156:159], v[96:99], v[80:83], v[156:159]
    v_mfma_f32_16x16x32_bf16 v[160:163], v[100:103], v[80:83], v[160:163]
    v_mfma_f32_16x16x32_bf16 v[164:167], v[104:107], v[80:83], v[164:167]
    v_mfma_f32_16x16x32_bf16 v[168:171], v[80:83], v[108:111], v[168:171]
    v_mfma_f32_16x16x32_bf16 v[172:175], v[80:83], v[112:115], v[172:175]
    v_mfma_f32_16x16x32_bf16 v[176:179], v[92:95], v[84:87], v[176:179]
    v_mfma_f32_16x16x32_bf16 v[180:183], v[96:99], v[84:87], v[180:183]
    v_mfma_f32_16x16x32_bf16 v[184:187], v[100:103], v[84:87], v[184:187]
    v_mfma_f32_16x16x32_bf16 v[188:191], v[104:107], v[84:87], v[188:191]
    v_mfma_f32_16x16x32_bf16 v[192:195], v[84:87], v[108:111], v[192:195]
    v_mfma_f32_16x16x32_bf16 v[196:199], v[84:87], v[112:115], v[196:199]
    v_mfma_f32_16x16x32_bf16 v[200:203], v[92:95], v[88:91], v[200:203]
    v_mfma_f32_16x16x32_bf16 v[204:207], v[96:99], v[88:91], v[204:207]
    v_mfma_f32_16x16x32_bf16 v[208:211], v[100:103], v[88:91], v[208:211]
    v_mfma_f32_16x16x32_bf16 v[212:215], v[104:107], v[88:91], v[212:215]
    v_mfma_f32_16x16x32_bf16 v[216:219], v[88:91], v[108:111], v[216:219]
    v_mfma_f32_16x16x32_bf16 v[220:223], v[88:91], v[112:115], v[220:223]
    s_mov_b32 s40, s48
    s_mov_b32 s41, s49
    s_and_b32 s41, s41, 0xffff
    s_mov_b32 s42, 0x700000
    s_mov_b32 s43, 0x00020000
    buffer_load_dword v30, v31, s[40:43], 0 offen
    s_mov_b32 s40, s44
    s_mov_b32 s41, s45
    s_and_b32 s41, s41, 0xffff
    s_mov_b32 s42, 0x200000
    s_mov_b32 s43, 0x00020000
    buffer_load_dword v30, v31, s[40:43], 0 offen
    s_waitcnt vmcnt(2)
    s_add_u32 s40, s4, 0x1800000
    s_addc_u32 s41, s5, 0
    s_and_b32 s41, s41, 0xffff
    s_mov_b32 s42, 0x800000
    s_mov_b32 s43, 0x00020000
    s_add_u32 s44, s4, 0x2000000
    s_addc_u32 s45, s5, 0
    s_and_b32 s45, s45, 0xffff
    s_mov_b32 s46, 0x400000
    s_mov_b32 s47, 0x00020000
    s_mov_b32 s48, 0x3fb8aa3b
    s_mov_b32 s49, 0x3fb8aa3b
    s_mul_i32 s50, s20, 12288
    v_lshl_or_b32 v240, v225, 16, v224
    v_lshl_or_b32 v241, v227, 16, v226
    v_lshl_or_b32 v242, v229, 16, v228
    v_lshl_or_b32 v243, v231, 16, v230
    v_lshl_or_b32 v244, v233, 16, v232
    v_lshl_or_b32 v245, v235, 16, v234
    v_lshl_or_b32 v246, v237, 16, v236
    v_lshl_or_b32 v247, v239, 16, v238
    s_movk_i32 s28, 160
    v_mul_lo_u32 v5, v3, s28
    v_lshl_add_u32 v5, v4, 3, v5
    v_add_u32 v5, s50, v5
    v_bfe_u32 v6, v1, 2, 2
    v_lshl_add_u32 v6, v4, 2, v6
    v_mul_lo_u32 v6, v6, s28
    v_and_b32 v7, 3, v1
    v_lshl_add_u32 v6, v7, 3, v6
    v_add_u32 v6, s50, v6
    v_lshlrev_b32 v7, 4, v1
    s_barrier
    v_cvt_pk_bf16_f32 v96, v136, v137
    v_cvt_pk_bf16_f32 v97, v138, v139
    v_cvt_pk_bf16_f32 v98, v140, v141
    v_cvt_pk_bf16_f32 v99, v142, v143
    v_cvt_pk_bf16_f32 v100, v160, v161
    v_cvt_pk_bf16_f32 v101, v162, v163
    v_cvt_pk_bf16_f32 v102, v164, v165
    v_cvt_pk_bf16_f32 v103, v166, v167
    v_cvt_pk_bf16_f32 v104, v184, v185
    v_cvt_pk_bf16_f32 v105, v186, v187
    v_cvt_pk_bf16_f32 v106, v188, v189
    v_cvt_pk_bf16_f32 v107, v190, v191
    v_cvt_pk_bf16_f32 v108, v208, v209
    v_cvt_pk_bf16_f32 v109, v210, v211
    v_cvt_pk_bf16_f32 v110, v212, v213
    v_cvt_pk_bf16_f32 v111, v214, v215
    s_nop 1
    v_mfma_f32_16x16x32_bf16 v[136:139], v[240:243], v[96:99], 0
    v_mfma_f32_16x16x32_bf16 v[140:143], v[244:247], v[96:99], 0
    v_mfma_f32_16x16x32_bf16 v[160:163], v[240:243], v[100:103], 0
    v_mfma_f32_16x16x32_bf16 v[164:167], v[244:247], v[100:103], 0
    v_mfma_f32_16x16x32_bf16 v[184:187], v[240:243], v[104:107], 0
    v_mfma_f32_16x16x32_bf16 v[188:191], v[244:247], v[104:107], 0
    v_mfma_f32_16x16x32_bf16 v[208:211], v[240:243], v[108:111], 0
    v_mfma_f32_16x16x32_bf16 v[212:215], v[244:247], v[108:111], 0
    s_nop 7
    v_cvt_pk_bf16_f32 v32, v136, v137
    v_cvt_pk_bf16_f32 v33, v138, v139
    v_cvt_pk_bf16_f32 v34, v140, v141
    v_cvt_pk_bf16_f32 v35, v142, v143
    v_cvt_pk_bf16_f32 v48, v160, v161
    v_cvt_pk_bf16_f32 v49, v162, v163
    v_cvt_pk_bf16_f32 v50, v164, v165
    v_cvt_pk_bf16_f32 v51, v166, v167
    v_cvt_pk_bf16_f32 v64, v184, v185
    v_cvt_pk_bf16_f32 v65, v186, v187
    v_cvt_pk_bf16_f32 v66, v188, v189
    v_cvt_pk_bf16_f32 v67, v190, v191
    v_cvt_pk_bf16_f32 v80, v208, v209
    v_cvt_pk_bf16_f32 v81, v210, v211
    v_cvt_pk_bf16_f32 v82, v212, v213
    v_cvt_pk_bf16_f32 v83, v214, v215
    v_lshlrev_b32 v136, 16, v32
    v_and_b32 v137, 0xffff0000, v32
    v_lshlrev_b32 v138, 16, v33
    v_and_b32 v139, 0xffff0000, v33
    v_lshlrev_b32 v140, 16, v34
    v_and_b32 v141, 0xffff0000, v34
    v_lshlrev_b32 v142, 16, v35
    v_and_b32 v143, 0xffff0000, v35
    v_lshlrev_b32 v160, 16, v48
    v_and_b32 v161, 0xffff0000, v48
    v_lshlrev_b32 v162, 16, v49
    v_and_b32 v163, 0xffff0000, v49
    v_lshlrev_b32 v164, 16, v50
    v_and_b32 v165, 0xffff0000, v50
    v_lshlrev_b32 v166, 16, v51
    v_and_b32 v167, 0xffff0000, v51
    v_lshlrev_b32 v184, 16, v64
    v_and_b32 v185, 0xffff0000, v64
    v_lshlrev_b32 v186, 16, v65
    v_and_b32 v187, 0xffff0000, v65
    v_lshlrev_b32 v188, 16, v66
    v_and_b32 v189, 0xffff0000, v66
    v_lshlrev_b32 v190, 16, v67
    v_and_b32 v191, 0xffff0000, v67
    v_lshlrev_b32 v208, 16, v80
    v_and_b32 v209, 0xffff0000, v80
    v_lshlrev_b32 v210, 16, v81
    v_and_b32 v211, 0xffff0000, v81
    v_lshlrev_b32 v212, 16, v82
    v_and_b32 v213, 0xffff0000, v82
    v_lshlrev_b32 v214, 16, v83
    v_and_b32 v215, 0xffff0000, v83
    v_max3_f32 v112, v136, v137, v138
    v_max3_f32 v114, v160, v161, v162
    v_max3_f32 v116, v184, v185, v186
    v_max3_f32 v118, v208, v209, v210
    v_max3_f32 v112, v112, v139, v140
    v_max3_f32 v114, v114, v163, v164
    v_max3_f32 v116, v116, v187, v188
    v_max3_f32 v118, v118, v211, v212
    v_max3_f32 v112, v112, v141, v142
    v_max3_f32 v114, v114, v165, v166
    v_max3_f32 v116, v116, v189, v190
    v_max3_f32 v118, v118, v213, v214
    v_max_f32 v112, v112, v143
    v_max_f32 v114, v114, v167
    v_max_f32 v116, v116, v191
    v_max_f32 v118, v118, v215
    v_min3_f32 v120, v136, v137, v138
    v_min3_f32 v122, v160, v161, v162
    v_min3_f32 v124, v184, v185, v186
    v_min3_f32 v126, v208, v209, v210
    v_min3_f32 v120, v120, v139, v140
    v_min3_f32 v122, v122, v163, v164
    v_min3_f32 v124, v124, v187, v188
    v_min3_f32 v126, v126, v211, v212
    v_min3_f32 v120, v120, v141, v142
    v_min3_f32 v122, v122, v165, v166
    v_min3_f32 v124, v124, v189, v190
    v_min3_f32 v126, v126, v213, v214
    v_min_f32 v120, v120, v143
    v_min_f32 v122, v122, v167
    v_min_f32 v124, v124, v191
    v_min_f32 v126, v126, v215
    v_mov_b32 v113, v112
    v_mov_b32 v115, v114
    v_mov_b32 v117, v116
    v_mov_b32 v119, v118
    v_mov_b32 v121, v120
    v_mov_b32 v123, v122
    v_mov_b32 v125, v124
    v_mov_b32 v127, v126
    s_nop 0
    v_permlane16_swap_b32 v112, v113
    v_permlane16_swap_b32 v114, v115
    v_permlane16_swap_b32 v116, v117
    v_permlane16_swap_b32 v118, v119
    v_permlane16_swap_b32 v120, v121
    v_permlane16_swap_b32 v122, v123
    v_permlane16_swap_b32 v124, v125
    v_permlane16_swap_b32 v126, v127
    s_nop 0
    v_max_f32 v112, v112, v113
    v_max_f32 v114, v114, v115
    v_max_f32 v116, v116, v117
    v_max_f32 v118, v118, v119
    v_min_f32 v120, v120, v121
    v_min_f32 v122, v122, v123
    v_min_f32 v124, v124, v125
    v_min_f32 v126, v126, v127
    v_mov_b32 v113, v112
    v_mov_b32 v115, v114
    v_mov_b32 v117, v116
    v_mov_b32 v119, v118
    v_mov_b32 v121, v120
    v_mov_b32 v123, v122
    v_mov_b32 v125, v124
    v_mov_b32 v127, v126
    s_nop 0
    v_permlane32_swap_b32 v112, v113
    v_permlane32_swap_b32 v114, v115
    v_permlane32_swap_b32 v116, v117
    v_permlane32_swap_b32 v118, v119
    v_permlane32_swap_b32 v120, v121
    v_permlane32_swap_b32 v122, v123
    v_permlane32_swap_b32 v124, v125
    v_permlane32_swap_b32 v126, v127
    s_nop 0
    v_max_f32 v112, v112, v113
    v_max_f32 v114, v114, v115
    v_max_f32 v116, v116, v117
    v_max_f32 v118, v118, v119
    v_min_f32 v120, v120, v121
    v_min_f32 v122, v122, v123
    v_min_f32 v124, v124, v125
    v_min_f32 v126, v126, v127
    v_mul_f32 v112, s48, v112
    v_mul_f32 v120, s48, v120
    v_mul_f32 v114, s48, v114
    v_mul_f32 v122, s48, v122
    v_mul_f32 v116, s48, v116
    v_mul_f32 v124, s48, v124
    v_mul_f32 v118, s48, v118
    v_mul_f32 v126, s48, v126
    v_pk_fma_f32 v[32:33], v[136:137], s[48:49], v[112:113] op_sel_hi:[1,1,0] neg_lo:[0,0,1] neg_hi:[0,0,1]
    v_pk_fma_f32 v[40:41], v[136:137], s[48:49], v[120:121] op_sel_hi:[1,1,0] neg_lo:[1,0,0] neg_hi:[1,0,0]
    v_pk_fma_f32 v[34:35], v[138:139], s[48:49], v[112:113] op_sel_hi:[1,1,0] neg_lo:[0,0,1] neg_hi:[0,0,1]
    v_pk_fma_f32 v[42:43], v[138:139], s[48:49], v[120:121] op_sel_hi:[1,1,0] neg_lo:[1,0,0] neg_hi:[1,0,0]
    v_pk_fma_f32 v[36:37], v[140:141], s[48:49], v[112:113] op_sel_hi:[1,1,0] neg_lo:[0,0,1] neg_hi:[0,0,1]
    v_pk_fma_f32 v[44:45], v[140:141], s[48:49], v[120:121] op_sel_hi:[1,1,0] neg_lo:[1,0,0] neg_hi:[1,0,0]
    v_pk_fma_f32 v[38:39], v[142:143], s[48:49], v[112:113] op_sel_hi:[1,1,0] neg_lo:[0,0,1] neg_hi:[0,0,1]
    v_pk_fma_f32 v[46:47], v[142:143], s[48:49], v[120:121] op_sel_hi:[1,1,0] neg_lo:[1,0,0] neg_hi:[1,0,0]
    v_pk_fma_f32 v[48:49], v[160:161], s[48:49], v[114:115] op_sel_hi:[1,1,0] neg_lo:[0,0,1] neg_hi:[0,0,1]
    v_pk_fma_f32 v[56:57], v[160:161], s[48:49], v[122:123] op_sel_hi:[1,1,0] neg_lo:[1,0,0] neg_hi:[1,0,0]
    v_pk_fma_f32 v[50:51], v[162:163], s[48:49], v[114:115] op_sel_hi:[1,1,0] neg_lo:[0,0,1] neg_hi:[0,0,1]
    v_pk_fma_f32 v[58:59], v[162:163], s[48:49], v[122:123] op_sel_hi:[1,1,0] neg_lo:[1,0,0] neg_hi:[1,0,0]
    v_pk_fma_f32 v[52:53], v[164:165], s[48:49], v[114:115] op_sel_hi:[1,1,0] neg_lo:[0,0,1] neg_hi:[0,0,1]
    v_pk_fma_f32 v[60:61], v[164:165], s[48:49], v[122:123] op_sel_hi:[1,1,0] neg_lo:[1,0,0] neg_hi:[1,0,0]
    v_pk_fma_f32 v[54:55], v[166:167], s[48:49], v[114:115] op_sel_hi:[1,1,0] neg_lo:[0,0,1] neg_hi:[0,0,1]
    v_pk_fma_f32 v[62:63], v[166:167], s[48:49], v[122:123] op_sel_hi:[1,1,0] neg_lo:[1,0,0] neg_hi:[1,0,0]
    v_pk_fma_f32 v[64:65], v[184:185], s[48:49], v[116:117] op_sel_hi:[1,1,0] neg_lo:[0,0,1] neg_hi:[0,0,1]
    v_pk_fma_f32 v[72:73], v[184:185], s[48:49], v[124:125] op_sel_hi:[1,1,0] neg_lo:[1,0,0] neg_hi:[1,0,0]
    v_pk_fma_f32 v[66:67], v[186:187], s[48:49], v[116:117] op_sel_hi:[1,1,0] neg_lo:[0,0,1] neg_hi:[0,0,1]
    v_pk_fma_f32 v[74:75], v[186:187], s[48:49], v[124:125] op_sel_hi:[1,1,0] neg_lo:[1,0,0] neg_hi:[1,0,0]
    v_pk_fma_f32 v[68:69], v[188:189], s[48:49], v[116:117] op_sel_hi:[1,1,0] neg_lo:[0,0,1] neg_hi:[0,0,1]
    v_pk_fma_f32 v[76:77], v[188:189], s[48:49], v[124:125] op_sel_hi:[1,1,0] neg_lo:[1,0,0] neg_hi:[1,0,0]
    v_pk_fma_f32 v[70:71], v[190:191], s[48:49], v[116:117] op_sel_hi:[1,1,0] neg_lo:[0,0,1] neg_hi:[0,0,1]
    v_pk_fma_f32 v[78:79], v[190:191], s[48:49], v[124:125] op_sel_hi:[1,1,0] neg_lo:[1,0,0] neg_hi:[1,0,0]
    v_pk_fma_f32 v[80:81], v[208:209], s[48:49], v[118:119] op_sel_hi:[1,1,0] neg_lo:[0,0,1] neg_hi:[0,0,1]
    v_pk_fma_f32 v[88:89], v[208:209], s[48:49], v[126:127] op_sel_hi:[1,1,0] neg_lo:[1,0,0] neg_hi:[1,0,0]
    v_pk_fma_f32 v[82:83], v[210:211], s[48:49], v[118:119] op_sel_hi:[1,1,0] neg_lo:[0,0,1] neg_hi:[0,0,1]
    v_pk_fma_f32 v[90:91], v[210:211], s[48:49], v[126:127] op_sel_hi:[1,1,0] neg_lo:[1,0,0] neg_hi:[1,0,0]
    v_pk_fma_f32 v[84:85], v[212:213], s[48:49], v[118:119] op_sel_hi:[1,1,0] neg_lo:[0,0,1] neg_hi:[0,0,1]
    v_pk_fma_f32 v[92:93], v[212:213], s[48:49], v[126:127] op_sel_hi:[1,1,0] neg_lo:[1,0,0] neg_hi:[1,0,0]
    v_pk_fma_f32 v[86:87], v[214:215], s[48:49], v[118:119] op_sel_hi:[1,1,0] neg_lo:[0,0,1] neg_hi:[0,0,1]
    v_pk_fma_f32 v[94:95], v[214:215], s[48:49], v[126:127] op_sel_hi:[1,1,0] neg_lo:[1,0,0] neg_hi:[1,0,0]
    v_exp_f32 v32, v32
    v_exp_f32 v33, v33
    v_exp_f32 v34, v34
    v_exp_f32 v35, v35
    v_exp_f32 v36, v36
    v_exp_f32 v37, v37
    v_exp_f32 v38, v38
    v_exp_f32 v39, v39
    v_exp_f32 v40, v40
    v_exp_f32 v41, v41
    v_exp_f32 v42, v42
    v_exp_f32 v43, v43
    v_exp_f32 v44, v44
    v_exp_f32 v45, v45
    v_exp_f32 v46, v46
    v_exp_f32 v47, v47
    v_exp_f32 v48, v48
    v_exp_f32 v49, v49
    v_exp_f32 v50, v50
    v_exp_f32 v51, v51
    v_exp_f32 v52, v52
    v_exp_f32 v53, v53
    v_exp_f32 v54, v54
    v_exp_f32 v55, v55
    v_exp_f32 v56, v56
    v_exp_f32 v57, v57
    v_exp_f32 v58, v58
    v_exp_f32 v59, v59
    v_exp_f32 v60, v60
    v_exp_f32 v61, v61
    v_exp_f32 v62, v62
    v_exp_f32 v63, v63
    v_exp_f32 v64, v64
    v_exp_f32 v65, v65
    v_exp_f32 v66, v66
    v_exp_f32 v67, v67
    v_exp_f32 v68, v68
    v_exp_f32 v69, v69
    v_exp_f32 v70, v70
    v_exp_f32 v71, v71
    v_exp_f32 v72, v72
    v_exp_f32 v73, v73
    v_exp_f32 v74, v74
    v_exp_f32 v75, v75
    v_exp_f32 v76, v76
    v_exp_f32 v77, v77
    v_exp_f32 v78, v78
    v_exp_f32 v79, v79
    v_exp_f32 v80, v80
    v_exp_f32 v81, v81
    v_exp_f32 v82, v82
    v_exp_f32 v83, v83
    v_exp_f32 v84, v84
    v_exp_f32 v85, v85
    v_exp_f32 v86, v86
    v_exp_f32 v87, v87
    v_exp_f32 v88, v88
    v_exp_f32 v89, v89
    v_exp_f32 v90, v90
    v_exp_f32 v91, v91
    v_exp_f32 v92, v92
    v_exp_f32 v93, v93
    v_exp_f32 v94, v94
    v_exp_f32 v95, v95
    s_nop 0
    v_pk_add_f32 v[112:113], v[32:33], v[34:35]
    v_pk_add_f32 v[114:115], v[48:49], v[50:51]
    v_pk_add_f32 v[116:117], v[64:65], v[66:67]
    v_pk_add_f32 v[118:119], v[80:81], v[82:83]
    v_pk_add_f32 v[112:113], v[112:113], v[36:37]
    v_pk_add_f32 v[114:115], v[114:115], v[52:53]
    v_pk_add_f32 v[116:117], v[116:117], v[68:69]
    v_pk_add_f32 v[118:119], v[118:119], v[84:85]
    v_pk_add_f32 v[112:113], v[112:113], v[38:39]
    v_pk_add_f32 v[114:115], v[114:115], v[54:55]
    v_pk_add_f32 v[116:117], v[116:117], v[70:71]
    v_pk_add_f32 v[118:119], v[118:119], v[86:87]
    v_add_f32 v112, v112, v113
    v_add_f32 v114, v114, v115
    v_add_f32 v116, v116, v117
    v_add_f32 v118, v118, v119
    v_pk_add_f32 v[120:121], v[40:41], v[42:43]
    v_pk_add_f32 v[122:123], v[56:57], v[58:59]
    v_pk_add_f32 v[124:125], v[72:73], v[74:75]
    v_pk_add_f32 v[126:127], v[88:89], v[90:91]
    v_pk_add_f32 v[120:121], v[120:121], v[44:45]
    v_pk_add_f32 v[122:123], v[122:123], v[60:61]
    v_pk_add_f32 v[124:125], v[124:125], v[76:77]
    v_pk_add_f32 v[126:127], v[126:127], v[92:93]
    v_pk_add_f32 v[120:121], v[120:121], v[46:47]
    v_pk_add_f32 v[122:123], v[122:123], v[62:63]
    v_pk_add_f32 v[124:125], v[124:125], v[78:79]
    v_pk_add_f32 v[126:127], v[126:127], v[94:95]
    v_add_f32 v120, v120, v121
    v_add_f32 v122, v122, v123
    v_add_f32 v124, v124, v125
    v_add_f32 v126, v126, v127
    v_mov_b32 v113, v112
    v_mov_b32 v115, v114
    v_mov_b32 v117, v116
    v_mov_b32 v119, v118
    v_mov_b32 v121, v120
    v_mov_b32 v123, v122
    v_mov_b32 v125, v124
    v_mov_b32 v127, v126
    s_nop 0
    v_permlane16_swap_b32 v112, v113
    v_permlane16_swap_b32 v114, v115
    v_permlane16_swap_b32 v116, v117
    v_permlane16_swap_b32 v118, v119
    v_permlane16_swap_b32 v120, v121
    v_permlane16_swap_b32 v122, v123
    v_permlane16_swap_b32 v124, v125
    v_permlane16_swap_b32 v126, v127
    s_nop 0
    v_add_f32 v112, v112, v113
    v_add_f32 v114, v114, v115
    v_add_f32 v116, v116, v117
    v_add_f32 v118, v118, v119
    v_add_f32 v120, v120, v121
    v_add_f32 v122, v122, v123
    v_add_f32 v124, v124, v125
    v_add_f32 v126, v126, v127
    v_mov_b32 v113, v112
    v_mov_b32 v115, v114
    v_mov_b32 v117, v116
    v_mov_b32 v119, v118
    v_mov_b32 v121, v120
    v_mov_b32 v123, v122
    v_mov_b32 v125, v124
    v_mov_b32 v127, v126
    s_nop 0
    v_permlane32_swap_b32 v112, v113
    v_permlane32_swap_b32 v114, v115
    v_permlane32_swap_b32 v116, v117
    v_permlane32_swap_b32 v118, v119
    v_permlane32_swap_b32 v120, v121
    v_permlane32_swap_b32 v122, v123
    v_permlane32_swap_b32 v124, v125
    v_permlane32_swap_b32 v126, v127
    s_nop 0
    v_add_f32 v112, v112, v113
    v_add_f32 v114, v114, v115
    v_add_f32 v116, v116, v117
    v_add_f32 v118, v118, v119
    v_add_f32 v120, v120, v121
    v_add_f32 v122, v122, v123
    v_add_f32 v124, v124, v125
    v_add_f32 v126, v126, v127
    v_rcp_f32 v112, v112
    v_rcp_f32 v120, v120
    v_rcp_f32 v114, v114
    v_rcp_f32 v122, v122
    v_rcp_f32 v116, v116
    v_rcp_f32 v124, v124
    v_rcp_f32 v118, v118
    v_rcp_f32 v126, v126
    s_nop 0
    v_pk_mul_f32 v[32:33], v[32:33], v[112:113] op_sel_hi:[1,0]
    v_pk_mul_f32 v[40:41], v[40:41], v[120:121] op_sel_hi:[1,0]
    v_pk_mul_f32 v[34:35], v[34:35], v[112:113] op_sel_hi:[1,0]
    v_pk_mul_f32 v[42:43], v[42:43], v[120:121] op_sel_hi:[1,0]
    v_pk_mul_f32 v[36:37], v[36:37], v[112:113] op_sel_hi:[1,0]
    v_pk_mul_f32 v[44:45], v[44:45], v[120:121] op_sel_hi:[1,0]
    v_pk_mul_f32 v[38:39], v[38:39], v[112:113] op_sel_hi:[1,0]
    v_pk_mul_f32 v[46:47], v[46:47], v[120:121] op_sel_hi:[1,0]
    v_pk_mul_f32 v[48:49], v[48:49], v[114:115] op_sel_hi:[1,0]
    v_pk_mul_f32 v[56:57], v[56:57], v[122:123] op_sel_hi:[1,0]
    v_pk_mul_f32 v[50:51], v[50:51], v[114:115] op_sel_hi:[1,0]
    v_pk_mul_f32 v[58:59], v[58:59], v[122:123] op_sel_hi:[1,0]
    v_pk_mul_f32 v[52:53], v[52:53], v[114:115] op_sel_hi:[1,0]
    v_pk_mul_f32 v[60:61], v[60:61], v[122:123] op_sel_hi:[1,0]
    v_pk_mul_f32 v[54:55], v[54:55], v[114:115] op_sel_hi:[1,0]
    v_pk_mul_f32 v[62:63], v[62:63], v[122:123] op_sel_hi:[1,0]
    v_pk_mul_f32 v[64:65], v[64:65], v[116:117] op_sel_hi:[1,0]
    v_pk_mul_f32 v[72:73], v[72:73], v[124:125] op_sel_hi:[1,0]
    v_pk_mul_f32 v[66:67], v[66:67], v[116:117] op_sel_hi:[1,0]
    v_pk_mul_f32 v[74:75], v[74:75], v[124:125] op_sel_hi:[1,0]
    v_pk_mul_f32 v[68:69], v[68:69], v[116:117] op_sel_hi:[1,0]
    v_pk_mul_f32 v[76:77], v[76:77], v[124:125] op_sel_hi:[1,0]
    v_pk_mul_f32 v[70:71], v[70:71], v[116:117] op_sel_hi:[1,0]
    v_pk_mul_f32 v[78:79], v[78:79], v[124:125] op_sel_hi:[1,0]
    v_pk_mul_f32 v[80:81], v[80:81], v[118:119] op_sel_hi:[1,0]
    v_pk_mul_f32 v[88:89], v[88:89], v[126:127] op_sel_hi:[1,0]
    v_pk_mul_f32 v[82:83], v[82:83], v[118:119] op_sel_hi:[1,0]
    v_pk_mul_f32 v[90:91], v[90:91], v[126:127] op_sel_hi:[1,0]
    v_pk_mul_f32 v[84:85], v[84:85], v[118:119] op_sel_hi:[1,0]
    v_pk_mul_f32 v[92:93], v[92:93], v[126:127] op_sel_hi:[1,0]
    v_pk_mul_f32 v[86:87], v[86:87], v[118:119] op_sel_hi:[1,0]
    v_pk_mul_f32 v[94:95], v[94:95], v[126:127] op_sel_hi:[1,0]
    v_cvt_pk_bf16_f32 v136, v32, v33
    v_cvt_pk_bf16_f32 v137, v34, v35
    v_cvt_pk_bf16_f32 v138, v36, v37
    v_cvt_pk_bf16_f32 v139, v38, v39
    v_cvt_pk_bf16_f32 v140, v40, v41
    v_cvt_pk_bf16_f32 v141, v42, v43
    v_cvt_pk_bf16_f32 v142, v44, v45
    v_cvt_pk_bf16_f32 v143, v46, v47
    v_cvt_pk_bf16_f32 v160, v48, v49
    v_cvt_pk_bf16_f32 v161, v50, v51
    v_cvt_pk_bf16_f32 v162, v52, v53
    v_cvt_pk_bf16_f32 v163, v54, v55
    v_cvt_pk_bf16_f32 v164, v56, v57
    v_cvt_pk_bf16_f32 v165, v58, v59
    v_cvt_pk_bf16_f32 v166, v60, v61
    v_cvt_pk_bf16_f32 v167, v62, v63
    v_cvt_pk_bf16_f32 v184, v64, v65
    v_cvt_pk_bf16_f32 v185, v66, v67
    v_cvt_pk_bf16_f32 v186, v68, v69
    v_cvt_pk_bf16_f32 v187, v70, v71
    v_cvt_pk_bf16_f32 v188, v72, v73
    v_cvt_pk_bf16_f32 v189, v74, v75
    v_cvt_pk_bf16_f32 v190, v76, v77
    v_cvt_pk_bf16_f32 v191, v78, v79
    v_cvt_pk_bf16_f32 v208, v80, v81
    v_cvt_pk_bf16_f32 v209, v82, v83
    v_cvt_pk_bf16_f32 v210, v84, v85
    v_cvt_pk_bf16_f32 v211, v86, v87
    v_cvt_pk_bf16_f32 v212, v88, v89
    v_cvt_pk_bf16_f32 v213, v90, v91
    v_cvt_pk_bf16_f32 v214, v92, v93
    v_cvt_pk_bf16_f32 v215, v94, v95
    ds_write_b64 v5, v[136:137] offset:0
    ds_write_b64 v5, v[138:139] offset:32
    ds_write_b64 v5, v[140:141] offset:64
    ds_write_b64 v5, v[142:143] offset:96
    ds_write_b64 v5, v[160:161] offset:2560
    ds_write_b64 v5, v[162:163] offset:2592
    ds_write_b64 v5, v[164:165] offset:2624
    ds_write_b64 v5, v[166:167] offset:2656
    ds_write_b64 v5, v[184:185] offset:5120
    ds_write_b64 v5, v[186:187] offset:5152
    ds_write_b64 v5, v[188:189] offset:5184
    ds_write_b64 v5, v[190:191] offset:5216
    ds_write_b64 v5, v[208:209] offset:7680
    ds_write_b64 v5, v[210:211] offset:7712
    ds_write_b64 v5, v[212:213] offset:7744
    ds_write_b64 v5, v[214:215] offset:7776
    v_cvt_pk_bf16_f32 v112, v144, v145
    v_cvt_pk_bf16_f32 v113, v146, v147
    v_cvt_pk_bf16_f32 v114, v168, v169
    v_cvt_pk_bf16_f32 v115, v170, v171
    v_cvt_pk_bf16_f32 v116, v148, v149
    v_cvt_pk_bf16_f32 v117, v150, v151
    v_cvt_pk_bf16_f32 v118, v172, v173
    v_cvt_pk_bf16_f32 v119, v174, v175
    v_cvt_pk_bf16_f32 v120, v192, v193
    v_cvt_pk_bf16_f32 v121, v194, v195
    v_cvt_pk_bf16_f32 v122, v216, v217
    v_cvt_pk_bf16_f32 v123, v218, v219
    v_cvt_pk_bf16_f32 v124, v196, v197
    v_cvt_pk_bf16_f32 v125, v198, v199
    v_cvt_pk_bf16_f32 v126, v220, v221
    v_cvt_pk_bf16_f32 v127, v222, v223
    v_mov_b32 v16, 0x3f803f80
    v_mov_b32 v17, 0x3f803f80
    v_mov_b32 v18, 0x3f803f80
    v_mov_b32 v19, 0x3f803f80
    s_waitcnt lgkmcnt(0)
    ds_read_b64_tr_b16 v[32:33], v6 offset:0
    ds_read_b64_tr_b16 v[34:35], v6 offset:2560
    ds_read_b64_tr_b16 v[36:37], v6 offset:32
    ds_read_b64_tr_b16 v[38:39], v6 offset:2592
    ds_read_b64_tr_b16 v[40:41], v6 offset:64
    ds_read_b64_tr_b16 v[42:43], v6 offset:2624
    ds_read_b64_tr_b16 v[44:45], v6 offset:96
    ds_read_b64_tr_b16 v[46:47], v6 offset:2656
    ds_read_b64_tr_b16 v[48:49], v6 offset:5120
    ds_read_b64_tr_b16 v[50:51], v6 offset:7680
    ds_read_b64_tr_b16 v[52:53], v6 offset:5152
    ds_read_b64_tr_b16 v[54:55], v6 offset:7712
    ds_read_b64_tr_b16 v[56:57], v6 offset:5184
    ds_read_b64_tr_b16 v[58:59], v6 offset:7744
    ds_read_b64_tr_b16 v[60:61], v6 offset:5216
    ds_read_b64_tr_b16 v[62:63], v6 offset:7776
    s_waitcnt lgkmcnt(8)
    v_mfma_f32_16x16x32_bf16 v[64:67], v[32:35], v[112:115], 0
    v_mfma_f32_16x16x32_bf16 v[68:71], v[32:35], v[116:119], 0
    v_mfma_f32_16x16x32_bf16 v[96:99], v[32:35], v[16:19], 0
    v_mfma_f32_16x16x32_bf16 v[72:75], v[36:39], v[112:115], 0
    v_mfma_f32_16x16x32_bf16 v[76:79], v[36:39], v[116:119], 0
    v_mfma_f32_16x16x32_bf16 v[100:103], v[36:39], v[16:19], 0
    v_mfma_f32_16x16x32_bf16 v[80:83], v[40:43], v[112:115], 0
    v_mfma_f32_16x16x32_bf16 v[84:87], v[40:43], v[116:119], 0
    v_mfma_f32_16x16x32_bf16 v[104:107], v[40:43], v[16:19], 0
    v_mfma_f32_16x16x32_bf16 v[88:91], v[44:47], v[112:115], 0
    v_mfma_f32_16x16x32_bf16 v[92:95], v[44:47], v[116:119], 0
    v_mfma_f32_16x16x32_bf16 v[108:111], v[44:47], v[16:19], 0
    s_waitcnt lgkmcnt(0)
    v_mfma_f32_16x16x32_bf16 v[64:67], v[48:51], v[120:123], v[64:67]
    v_mfma_f32_16x16x32_bf16 v[68:71], v[48:51], v[124:127], v[68:71]
    v_mfma_f32_16x16x32_bf16 v[96:99], v[48:51], v[16:19], v[96:99]
    v_mfma_f32_16x16x32_bf16 v[72:75], v[52:55], v[120:123], v[72:75]
    v_mfma_f32_16x16x32_bf16 v[76:79], v[52:55], v[124:127], v[76:79]
    v_mfma_f32_16x16x32_bf16 v[100:103], v[52:55], v[16:19], v[100:103]
    v_mfma_f32_16x16x32_bf16 v[80:83], v[56:59], v[120:123], v[80:83]
    v_mfma_f32_16x16x32_bf16 v[84:87], v[56:59], v[124:127], v[84:87]
    v_mfma_f32_16x16x32_bf16 v[104:107], v[56:59], v[16:19], v[104:107]
    v_mfma_f32_16x16x32_bf16 v[88:91], v[60:63], v[120:123], v[88:91]
    v_mfma_f32_16x16x32_bf16 v[92:95], v[60:63], v[124:127], v[92:95]
    v_mfma_f32_16x16x32_bf16 v[108:111], v[60:63], v[16:19], v[108:111]
    v_add_u32 v8, s50, v7
    s_nop 7
    ds_write_b128 v8, v[64:67] offset:0
    ds_write_b128 v8, v[68:71] offset:1024
    ds_write_b128 v8, v[72:75] offset:2048
    ds_write_b128 v8, v[76:79] offset:3072
    ds_write_b128 v8, v[80:83] offset:4096
    ds_write_b128 v8, v[84:87] offset:5120
    ds_write_b128 v8, v[88:91] offset:6144
    ds_write_b128 v8, v[92:95] offset:7168
    ds_write_b128 v8, v[96:99] offset:8192
    ds_write_b128 v8, v[100:103] offset:9216
    ds_write_b128 v8, v[104:107] offset:10240
    ds_write_b128 v8, v[108:111] offset:11264
    s_lshr_b32 s28, s20, 2
    s_mul_i32 s28, s28, 12288
    s_and_b32 s29, s20, 3
    s_mul_i32 s29, s29, 3072
    s_add_u32 s28, s28, s29
    v_add_u32 v8, s28, v7
    v_add_u32 v9, 0xc000, v8
    s_lshl_b32 s28, s25, 3
    s_add_u32 s28, s28, s23
    s_mul_i32 s28, s28, 24
    s_mul_i32 s29, s20, 3
    s_add_u32 s28, s28, s29
    s_lshl_b32 s28, s28, 10
    v_add_u32 v10, s28, v7
    s_waitcnt lgkmcnt(0)
    s_barrier
    ds_read_b128 v[32:35], v8 offset:0
    ds_read_b128 v[36:39], v8 offset:1024
    ds_read_b128 v[40:43], v8 offset:2048
    ds_read_b128 v[44:47], v8 offset:24576
    ds_read_b128 v[48:51], v8 offset:25600
    ds_read_b128 v[52:55], v8 offset:26624
    ds_read_b128 v[56:59], v9 offset:0
    ds_read_b128 v[60:63], v9 offset:1024
    ds_read_b128 v[64:67], v9 offset:2048
    ds_read_b128 v[68:71], v9 offset:24576
    ds_read_b128 v[72:75], v9 offset:25600
    ds_read_b128 v[76:79], v9 offset:26624
    s_waitcnt lgkmcnt(0)
    v_pk_add_f32 v[32:33], v[32:33], v[44:45]
    v_pk_add_f32 v[34:35], v[34:35], v[46:47]
    v_pk_add_f32 v[36:37], v[36:37], v[48:49]
    v_pk_add_f32 v[38:39], v[38:39], v[50:51]
    v_pk_add_f32 v[40:41], v[40:41], v[52:53]
    v_pk_add_f32 v[42:43], v[42:43], v[54:55]
    v_pk_add_f32 v[32:33], v[32:33], v[56:57]
    v_pk_add_f32 v[34:35], v[34:35], v[58:59]
    v_pk_add_f32 v[36:37], v[36:37], v[60:61]
    v_pk_add_f32 v[38:39], v[38:39], v[62:63]
    v_pk_add_f32 v[40:41], v[40:41], v[64:65]
    v_pk_add_f32 v[42:43], v[42:43], v[66:67]
    v_pk_add_f32 v[32:33], v[32:33], v[68:69]
    v_pk_add_f32 v[34:35], v[34:35], v[70:71]
    v_pk_add_f32 v[36:37], v[36:37], v[72:73]
    v_pk_add_f32 v[38:39], v[38:39], v[74:75]
    v_pk_add_f32 v[40:41], v[40:41], v[76:77]
    v_pk_add_f32 v[42:43], v[42:43], v[78:79]
    buffer_store_dwordx4 v[32:35], v10, s[44:47], 0 offen offset:0
    buffer_store_dwordx4 v[36:39], v10, s[44:47], 0 offen offset:1024
    buffer_store_dwordx4 v[40:43], v10, s[44:47], 0 offen offset:2048
    s_nop 1
    v_cvt_pk_bf16_f32 v96, v128, v129
    v_cvt_pk_bf16_f32 v97, v130, v131
    v_cvt_pk_bf16_f32 v98, v132, v133
    v_cvt_pk_bf16_f32 v99, v134, v135
    v_cvt_pk_bf16_f32 v100, v152, v153
    v_cvt_pk_bf16_f32 v101, v154, v155
    v_cvt_pk_bf16_f32 v102, v156, v157
    v_cvt_pk_bf16_f32 v103, v158, v159
    v_cvt_pk_bf16_f32 v104, v176, v177
    v_cvt_pk_bf16_f32 v105, v178, v179
    v_cvt_pk_bf16_f32 v106, v180, v181
    v_cvt_pk_bf16_f32 v107, v182, v183
    v_cvt_pk_bf16_f32 v108, v200, v201
    v_cvt_pk_bf16_f32 v109, v202, v203
    v_cvt_pk_bf16_f32 v110, v204, v205
    v_cvt_pk_bf16_f32 v111, v206, v207
    s_nop 1
    v_mfma_f32_16x16x32_bf16 v[128:131], v[240:243], v[96:99], 0
    v_mfma_f32_16x16x32_bf16 v[132:135], v[244:247], v[96:99], 0
    v_mfma_f32_16x16x32_bf16 v[152:155], v[240:243], v[100:103], 0
    v_mfma_f32_16x16x32_bf16 v[156:159], v[244:247], v[100:103], 0
    v_mfma_f32_16x16x32_bf16 v[176:179], v[240:243], v[104:107], 0
    v_mfma_f32_16x16x32_bf16 v[180:183], v[244:247], v[104:107], 0
    v_mfma_f32_16x16x32_bf16 v[200:203], v[240:243], v[108:111], 0
    v_mfma_f32_16x16x32_bf16 v[204:207], v[244:247], v[108:111], 0
    s_nop 7
    v_cvt_pk_bf16_f32 v32, v128, v129
    v_cvt_pk_bf16_f32 v33, v130, v131
    v_cvt_pk_bf16_f32 v34, v132, v133
    v_cvt_pk_bf16_f32 v35, v134, v135
    v_cvt_pk_bf16_f32 v48, v152, v153
    v_cvt_pk_bf16_f32 v49, v154, v155
    v_cvt_pk_bf16_f32 v50, v156, v157
    v_cvt_pk_bf16_f32 v51, v158, v159
    v_cvt_pk_bf16_f32 v64, v176, v177
    v_cvt_pk_bf16_f32 v65, v178, v179
    v_cvt_pk_bf16_f32 v66, v180, v181
    v_cvt_pk_bf16_f32 v67, v182, v183
    v_cvt_pk_bf16_f32 v80, v200, v201
    v_cvt_pk_bf16_f32 v81, v202, v203
    v_cvt_pk_bf16_f32 v82, v204, v205
    v_cvt_pk_bf16_f32 v83, v206, v207
    v_lshlrev_b32 v128, 16, v32
    v_and_b32 v129, 0xffff0000, v32
    v_lshlrev_b32 v130, 16, v33
    v_and_b32 v131, 0xffff0000, v33
    v_lshlrev_b32 v132, 16, v34
    v_and_b32 v133, 0xffff0000, v34
    v_lshlrev_b32 v134, 16, v35
    v_and_b32 v135, 0xffff0000, v35
    v_lshlrev_b32 v152, 16, v48
    v_and_b32 v153, 0xffff0000, v48
    v_lshlrev_b32 v154, 16, v49
    v_and_b32 v155, 0xffff0000, v49
    v_lshlrev_b32 v156, 16, v50
    v_and_b32 v157, 0xffff0000, v50
    v_lshlrev_b32 v158, 16, v51
    v_and_b32 v159, 0xffff0000, v51
    v_lshlrev_b32 v176, 16, v64
    v_and_b32 v177, 0xffff0000, v64
    v_lshlrev_b32 v178, 16, v65
    v_and_b32 v179, 0xffff0000, v65
    v_lshlrev_b32 v180, 16, v66
    v_and_b32 v181, 0xffff0000, v66
    v_lshlrev_b32 v182, 16, v67
    v_and_b32 v183, 0xffff0000, v67
    v_lshlrev_b32 v200, 16, v80
    v_and_b32 v201, 0xffff0000, v80
    v_lshlrev_b32 v202, 16, v81
    v_and_b32 v203, 0xffff0000, v81
    v_lshlrev_b32 v204, 16, v82
    v_and_b32 v205, 0xffff0000, v82
    v_lshlrev_b32 v206, 16, v83
    v_and_b32 v207, 0xffff0000, v83
    v_max3_f32 v112, v128, v129, v130
    v_max3_f32 v114, v152, v153, v154
    v_max3_f32 v116, v176, v177, v178
    v_max3_f32 v118, v200, v201, v202
    v_max3_f32 v112, v112, v131, v132
    v_max3_f32 v114, v114, v155, v156
    v_max3_f32 v116, v116, v179, v180
    v_max3_f32 v118, v118, v203, v204
    v_max3_f32 v112, v112, v133, v134
    v_max3_f32 v114, v114, v157, v158
    v_max3_f32 v116, v116, v181, v182
    v_max3_f32 v118, v118, v205, v206
    v_max_f32 v112, v112, v135
    v_max_f32 v114, v114, v159
    v_max_f32 v116, v116, v183
    v_max_f32 v118, v118, v207
    v_min3_f32 v120, v128, v129, v130
    v_min3_f32 v122, v152, v153, v154
    v_min3_f32 v124, v176, v177, v178
    v_min3_f32 v126, v200, v201, v202
    v_min3_f32 v120, v120, v131, v132
    v_min3_f32 v122, v122, v155, v156
    v_min3_f32 v124, v124, v179, v180
    v_min3_f32 v126, v126, v203, v204
    v_min3_f32 v120, v120, v133, v134
    v_min3_f32 v122, v122, v157, v158
    v_min3_f32 v124, v124, v181, v182
    v_min3_f32 v126, v126, v205, v206
    v_min_f32 v120, v120, v135
    v_min_f32 v122, v122, v159
    v_min_f32 v124, v124, v183
    v_min_f32 v126, v126, v207
    v_mov_b32 v113, v112
    v_mov_b32 v115, v114
    v_mov_b32 v117, v116
    v_mov_b32 v119, v118
    v_mov_b32 v121, v120
    v_mov_b32 v123, v122
    v_mov_b32 v125, v124
    v_mov_b32 v127, v126
    s_nop 0
    v_permlane16_swap_b32 v112, v113
    v_permlane16_swap_b32 v114, v115
    v_permlane16_swap_b32 v116, v117
    v_permlane16_swap_b32 v118, v119
    v_permlane16_swap_b32 v120, v121
    v_permlane16_swap_b32 v122, v123
    v_permlane16_swap_b32 v124, v125
    v_permlane16_swap_b32 v126, v127
    s_nop 0
    v_max_f32 v112, v112, v113
    v_max_f32 v114, v114, v115
    v_max_f32 v116, v116, v117
    v_max_f32 v118, v118, v119
    v_min_f32 v120, v120, v121
    v_min_f32 v122, v122, v123
    v_min_f32 v124, v124, v125
    v_min_f32 v126, v126, v127
    v_mov_b32 v113, v112
    v_mov_b32 v115, v114
    v_mov_b32 v117, v116
    v_mov_b32 v119, v118
    v_mov_b32 v121, v120
    v_mov_b32 v123, v122
    v_mov_b32 v125, v124
    v_mov_b32 v127, v126
    s_nop 0
    v_permlane32_swap_b32 v112, v113
    v_permlane32_swap_b32 v114, v115
    v_permlane32_swap_b32 v116, v117
    v_permlane32_swap_b32 v118, v119
    v_permlane32_swap_b32 v120, v121
    v_permlane32_swap_b32 v122, v123
    v_permlane32_swap_b32 v124, v125
    v_permlane32_swap_b32 v126, v127
    s_nop 0
    v_max_f32 v112, v112, v113
    v_max_f32 v114, v114, v115
    v_max_f32 v116, v116, v117
    v_max_f32 v118, v118, v119
    v_min_f32 v120, v120, v121
    v_min_f32 v122, v122, v123
    v_min_f32 v124, v124, v125
    v_min_f32 v126, v126, v127
    v_mul_f32 v112, s48, v112
    v_mul_f32 v120, s48, v120
    v_mul_f32 v114, s48, v114
    v_mul_f32 v122, s48, v122
    v_mul_f32 v116, s48, v116
    v_mul_f32 v124, s48, v124
    v_mul_f32 v118, s48, v118
    v_mul_f32 v126, s48, v126
    v_pk_fma_f32 v[32:33], v[128:129], s[48:49], v[112:113] op_sel_hi:[1,1,0] neg_lo:[0,0,1] neg_hi:[0,0,1]
    v_pk_fma_f32 v[40:41], v[128:129], s[48:49], v[120:121] op_sel_hi:[1,1,0] neg_lo:[1,0,0] neg_hi:[1,0,0]
    v_pk_fma_f32 v[34:35], v[130:131], s[48:49], v[112:113] op_sel_hi:[1,1,0] neg_lo:[0,0,1] neg_hi:[0,0,1]
    v_pk_fma_f32 v[42:43], v[130:131], s[48:49], v[120:121] op_sel_hi:[1,1,0] neg_lo:[1,0,0] neg_hi:[1,0,0]
    v_pk_fma_f32 v[36:37], v[132:133], s[48:49], v[112:113] op_sel_hi:[1,1,0] neg_lo:[0,0,1] neg_hi:[0,0,1]
    v_pk_fma_f32 v[44:45], v[132:133], s[48:49], v[120:121] op_sel_hi:[1,1,0] neg_lo:[1,0,0] neg_hi:[1,0,0]
    v_pk_fma_f32 v[38:39], v[134:135], s[48:49], v[112:113] op_sel_hi:[1,1,0] neg_lo:[0,0,1] neg_hi:[0,0,1]
    v_pk_fma_f32 v[46:47], v[134:135], s[48:49], v[120:121] op_sel_hi:[1,1,0] neg_lo:[1,0,0] neg_hi:[1,0,0]
    v_pk_fma_f32 v[48:49], v[152:153], s[48:49], v[114:115] op_sel_hi:[1,1,0] neg_lo:[0,0,1] neg_hi:[0,0,1]
    v_pk_fma_f32 v[56:57], v[152:153], s[48:49], v[122:123] op_sel_hi:[1,1,0] neg_lo:[1,0,0] neg_hi:[1,0,0]
    v_pk_fma_f32 v[50:51], v[154:155], s[48:49], v[114:115] op_sel_hi:[1,1,0] neg_lo:[0,0,1] neg_hi:[0,0,1]
    v_pk_fma_f32 v[58:59], v[154:155], s[48:49], v[122:123] op_sel_hi:[1,1,0] neg_lo:[1,0,0] neg_hi:[1,0,0]
    v_pk_fma_f32 v[52:53], v[156:157], s[48:49], v[114:115] op_sel_hi:[1,1,0] neg_lo:[0,0,1] neg_hi:[0,0,1]
    v_pk_fma_f32 v[60:61], v[156:157], s[48:49], v[122:123] op_sel_hi:[1,1,0] neg_lo:[1,0,0] neg_hi:[1,0,0]
    v_pk_fma_f32 v[54:55], v[158:159], s[48:49], v[114:115] op_sel_hi:[1,1,0] neg_lo:[0,0,1] neg_hi:[0,0,1]
    v_pk_fma_f32 v[62:63], v[158:159], s[48:49], v[122:123] op_sel_hi:[1,1,0] neg_lo:[1,0,0] neg_hi:[1,0,0]
    v_pk_fma_f32 v[64:65], v[176:177], s[48:49], v[116:117] op_sel_hi:[1,1,0] neg_lo:[0,0,1] neg_hi:[0,0,1]
    v_pk_fma_f32 v[72:73], v[176:177], s[48:49], v[124:125] op_sel_hi:[1,1,0] neg_lo:[1,0,0] neg_hi:[1,0,0]
    v_pk_fma_f32 v[66:67], v[178:179], s[48:49], v[116:117] op_sel_hi:[1,1,0] neg_lo:[0,0,1] neg_hi:[0,0,1]
    v_pk_fma_f32 v[74:75], v[178:179], s[48:49], v[124:125] op_sel_hi:[1,1,0] neg_lo:[1,0,0] neg_hi:[1,0,0]
    v_pk_fma_f32 v[68:69], v[180:181], s[48:49], v[116:117] op_sel_hi:[1,1,0] neg_lo:[0,0,1] neg_hi:[0,0,1]
    v_pk_fma_f32 v[76:77], v[180:181], s[48:49], v[124:125] op_sel_hi:[1,1,0] neg_lo:[1,0,0] neg_hi:[1,0,0]
    v_pk_fma_f32 v[70:71], v[182:183], s[48:49], v[116:117] op_sel_hi:[1,1,0] neg_lo:[0,0,1] neg_hi:[0,0,1]
    v_pk_fma_f32 v[78:79], v[182:183], s[48:49], v[124:125] op_sel_hi:[1,1,0] neg_lo:[1,0,0] neg_hi:[1,0,0]
    v_pk_fma_f32 v[80:81], v[200:201], s[48:49], v[118:119] op_sel_hi:[1,1,0] neg_lo:[0,0,1] neg_hi:[0,0,1]
    v_pk_fma_f32 v[88:89], v[200:201], s[48:49], v[126:127] op_sel_hi:[1,1,0] neg_lo:[1,0,0] neg_hi:[1,0,0]
    v_pk_fma_f32 v[82:83], v[202:203], s[48:49], v[118:119] op_sel_hi:[1,1,0] neg_lo:[0,0,1] neg_hi:[0,0,1]
    v_pk_fma_f32 v[90:91], v[202:203], s[48:49], v[126:127] op_sel_hi:[1,1,0] neg_lo:[1,0,0] neg_hi:[1,0,0]
    v_pk_fma_f32 v[84:85], v[204:205], s[48:49], v[118:119] op_sel_hi:[1,1,0] neg_lo:[0,0,1] neg_hi:[0,0,1]
    v_pk_fma_f32 v[92:93], v[204:205], s[48:49], v[126:127] op_sel_hi:[1,1,0] neg_lo:[1,0,0] neg_hi:[1,0,0]
    v_pk_fma_f32 v[86:87], v[206:207], s[48:49], v[118:119] op_sel_hi:[1,1,0] neg_lo:[0,0,1] neg_hi:[0,0,1]
    v_pk_fma_f32 v[94:95], v[206:207], s[48:49], v[126:127] op_sel_hi:[1,1,0] neg_lo:[1,0,0] neg_hi:[1,0,0]
    v_exp_f32 v32, v32
    v_exp_f32 v33, v33
    v_exp_f32 v34, v34
    v_exp_f32 v35, v35
    v_exp_f32 v36, v36
    v_exp_f32 v37, v37
    v_exp_f32 v38, v38
    v_exp_f32 v39, v39
    v_exp_f32 v40, v40
    v_exp_f32 v41, v41
    v_exp_f32 v42, v42
    v_exp_f32 v43, v43
    v_exp_f32 v44, v44
    v_exp_f32 v45, v45
    v_exp_f32 v46, v46
    v_exp_f32 v47, v47
    v_exp_f32 v48, v48
    v_exp_f32 v49, v49
    v_exp_f32 v50, v50
    v_exp_f32 v51, v51
    v_exp_f32 v52, v52
    v_exp_f32 v53, v53
    v_exp_f32 v54, v54
    v_exp_f32 v55, v55
    v_exp_f32 v56, v56
    v_exp_f32 v57, v57
    v_exp_f32 v58, v58
    v_exp_f32 v59, v59
    v_exp_f32 v60, v60
    v_exp_f32 v61, v61
    v_exp_f32 v62, v62
    v_exp_f32 v63, v63
    v_exp_f32 v64, v64
    v_exp_f32 v65, v65
    v_exp_f32 v66, v66
    v_exp_f32 v67, v67
    v_exp_f32 v68, v68
    v_exp_f32 v69, v69
    v_exp_f32 v70, v70
    v_exp_f32 v71, v71
    v_exp_f32 v72, v72
    v_exp_f32 v73, v73
    v_exp_f32 v74, v74
    v_exp_f32 v75, v75
    v_exp_f32 v76, v76
    v_exp_f32 v77, v77
    v_exp_f32 v78, v78
    v_exp_f32 v79, v79
    v_exp_f32 v80, v80
    v_exp_f32 v81, v81
    v_exp_f32 v82, v82
    v_exp_f32 v83, v83
    v_exp_f32 v84, v84
    v_exp_f32 v85, v85
    v_exp_f32 v86, v86
    v_exp_f32 v87, v87
    v_exp_f32 v88, v88
    v_exp_f32 v89, v89
    v_exp_f32 v90, v90
    v_exp_f32 v91, v91
    v_exp_f32 v92, v92
    v_exp_f32 v93, v93
    v_exp_f32 v94, v94
    v_exp_f32 v95, v95
    s_nop 0
    v_pk_add_f32 v[112:113], v[32:33], v[34:35]
    v_pk_add_f32 v[114:115], v[48:49], v[50:51]
    v_pk_add_f32 v[116:117], v[64:65], v[66:67]
    v_pk_add_f32 v[118:119], v[80:81], v[82:83]
    v_pk_add_f32 v[112:113], v[112:113], v[36:37]
    v_pk_add_f32 v[114:115], v[114:115], v[52:53]
    v_pk_add_f32 v[116:117], v[116:117], v[68:69]
    v_pk_add_f32 v[118:119], v[118:119], v[84:85]
    v_pk_add_f32 v[112:113], v[112:113], v[38:39]
    v_pk_add_f32 v[114:115], v[114:115], v[54:55]
    v_pk_add_f32 v[116:117], v[116:117], v[70:71]
    v_pk_add_f32 v[118:119], v[118:119], v[86:87]
    v_add_f32 v112, v112, v113
    v_add_f32 v114, v114, v115
    v_add_f32 v116, v116, v117
    v_add_f32 v118, v118, v119
    v_pk_add_f32 v[120:121], v[40:41], v[42:43]
    v_pk_add_f32 v[122:123], v[56:57], v[58:59]
    v_pk_add_f32 v[124:125], v[72:73], v[74:75]
    v_pk_add_f32 v[126:127], v[88:89], v[90:91]
    v_pk_add_f32 v[120:121], v[120:121], v[44:45]
    v_pk_add_f32 v[122:123], v[122:123], v[60:61]
    v_pk_add_f32 v[124:125], v[124:125], v[76:77]
    v_pk_add_f32 v[126:127], v[126:127], v[92:93]
    v_pk_add_f32 v[120:121], v[120:121], v[46:47]
    v_pk_add_f32 v[122:123], v[122:123], v[62:63]
    v_pk_add_f32 v[124:125], v[124:125], v[78:79]
    v_pk_add_f32 v[126:127], v[126:127], v[94:95]
    v_add_f32 v120, v120, v121
    v_add_f32 v122, v122, v123
    v_add_f32 v124, v124, v125
    v_add_f32 v126, v126, v127
    v_mov_b32 v113, v112
    v_mov_b32 v115, v114
    v_mov_b32 v117, v116
    v_mov_b32 v119, v118
    v_mov_b32 v121, v120
    v_mov_b32 v123, v122
    v_mov_b32 v125, v124
    v_mov_b32 v127, v126
    s_nop 0
    v_permlane16_swap_b32 v112, v113
    v_permlane16_swap_b32 v114, v115
    v_permlane16_swap_b32 v116, v117
    v_permlane16_swap_b32 v118, v119
    v_permlane16_swap_b32 v120, v121
    v_permlane16_swap_b32 v122, v123
    v_permlane16_swap_b32 v124, v125
    v_permlane16_swap_b32 v126, v127
    s_nop 0
    v_add_f32 v112, v112, v113
    v_add_f32 v114, v114, v115
    v_add_f32 v116, v116, v117
    v_add_f32 v118, v118, v119
    v_add_f32 v120, v120, v121
    v_add_f32 v122, v122, v123
    v_add_f32 v124, v124, v125
    v_add_f32 v126, v126, v127
    v_mov_b32 v113, v112
    v_mov_b32 v115, v114
    v_mov_b32 v117, v116
    v_mov_b32 v119, v118
    v_mov_b32 v121, v120
    v_mov_b32 v123, v122
    v_mov_b32 v125, v124
    v_mov_b32 v127, v126
    s_nop 0
    v_permlane32_swap_b32 v112, v113
    v_permlane32_swap_b32 v114, v115
    v_permlane32_swap_b32 v116, v117
    v_permlane32_swap_b32 v118, v119
    v_permlane32_swap_b32 v120, v121
    v_permlane32_swap_b32 v122, v123
    v_permlane32_swap_b32 v124, v125
    v_permlane32_swap_b32 v126, v127
    s_nop 0
    v_add_f32 v112, v112, v113
    v_add_f32 v114, v114, v115
    v_add_f32 v116, v116, v117
    v_add_f32 v118, v118, v119
    v_add_f32 v120, v120, v121
    v_add_f32 v122, v122, v123
    v_add_f32 v124, v124, v125
    v_add_f32 v126, v126, v127
    v_rcp_f32 v112, v112
    v_rcp_f32 v120, v120
    v_rcp_f32 v114, v114
    v_rcp_f32 v122, v122
    v_rcp_f32 v116, v116
    v_rcp_f32 v124, v124
    v_rcp_f32 v118, v118
    v_rcp_f32 v126, v126
    s_nop 0
    v_pk_mul_f32 v[32:33], v[32:33], v[112:113] op_sel_hi:[1,0]
    v_pk_mul_f32 v[40:41], v[40:41], v[120:121] op_sel_hi:[1,0]
    v_pk_mul_f32 v[34:35], v[34:35], v[112:113] op_sel_hi:[1,0]
    v_pk_mul_f32 v[42:43], v[42:43], v[120:121] op_sel_hi:[1,0]
    v_pk_mul_f32 v[36:37], v[36:37], v[112:113] op_sel_hi:[1,0]
    v_pk_mul_f32 v[44:45], v[44:45], v[120:121] op_sel_hi:[1,0]
    v_pk_mul_f32 v[38:39], v[38:39], v[112:113] op_sel_hi:[1,0]
    v_pk_mul_f32 v[46:47], v[46:47], v[120:121] op_sel_hi:[1,0]
    v_pk_mul_f32 v[48:49], v[48:49], v[114:115] op_sel_hi:[1,0]
    v_pk_mul_f32 v[56:57], v[56:57], v[122:123] op_sel_hi:[1,0]
    v_pk_mul_f32 v[50:51], v[50:51], v[114:115] op_sel_hi:[1,0]
    v_pk_mul_f32 v[58:59], v[58:59], v[122:123] op_sel_hi:[1,0]
    v_pk_mul_f32 v[52:53], v[52:53], v[114:115] op_sel_hi:[1,0]
    v_pk_mul_f32 v[60:61], v[60:61], v[122:123] op_sel_hi:[1,0]
    v_pk_mul_f32 v[54:55], v[54:55], v[114:115] op_sel_hi:[1,0]
    v_pk_mul_f32 v[62:63], v[62:63], v[122:123] op_sel_hi:[1,0]
    v_pk_mul_f32 v[64:65], v[64:65], v[116:117] op_sel_hi:[1,0]
    v_pk_mul_f32 v[72:73], v[72:73], v[124:125] op_sel_hi:[1,0]
    v_pk_mul_f32 v[66:67], v[66:67], v[116:117] op_sel_hi:[1,0]
    v_pk_mul_f32 v[74:75], v[74:75], v[124:125] op_sel_hi:[1,0]
    v_pk_mul_f32 v[68:69], v[68:69], v[116:117] op_sel_hi:[1,0]
    v_pk_mul_f32 v[76:77], v[76:77], v[124:125] op_sel_hi:[1,0]
    v_pk_mul_f32 v[70:71], v[70:71], v[116:117] op_sel_hi:[1,0]
    v_pk_mul_f32 v[78:79], v[78:79], v[124:125] op_sel_hi:[1,0]
    v_pk_mul_f32 v[80:81], v[80:81], v[118:119] op_sel_hi:[1,0]
    v_pk_mul_f32 v[88:89], v[88:89], v[126:127] op_sel_hi:[1,0]
    v_pk_mul_f32 v[82:83], v[82:83], v[118:119] op_sel_hi:[1,0]
    v_pk_mul_f32 v[90:91], v[90:91], v[126:127] op_sel_hi:[1,0]
    v_pk_mul_f32 v[84:85], v[84:85], v[118:119] op_sel_hi:[1,0]
    v_pk_mul_f32 v[92:93], v[92:93], v[126:127] op_sel_hi:[1,0]
    v_pk_mul_f32 v[86:87], v[86:87], v[118:119] op_sel_hi:[1,0]
    v_pk_mul_f32 v[94:95], v[94:95], v[126:127] op_sel_hi:[1,0]
    v_cvt_pk_bf16_f32 v128, v32, v33
    v_cvt_pk_bf16_f32 v129, v34, v35
    v_cvt_pk_bf16_f32 v130, v36, v37
    v_cvt_pk_bf16_f32 v131, v38, v39
    v_cvt_pk_bf16_f32 v132, v40, v41
    v_cvt_pk_bf16_f32 v133, v42, v43
    v_cvt_pk_bf16_f32 v134, v44, v45
    v_cvt_pk_bf16_f32 v135, v46, v47
    v_cvt_pk_bf16_f32 v152, v48, v49
    v_cvt_pk_bf16_f32 v153, v50, v51
    v_cvt_pk_bf16_f32 v154, v52, v53
    v_cvt_pk_bf16_f32 v155, v54, v55
    v_cvt_pk_bf16_f32 v156, v56, v57
    v_cvt_pk_bf16_f32 v157, v58, v59
    v_cvt_pk_bf16_f32 v158, v60, v61
    v_cvt_pk_bf16_f32 v159, v62, v63
    v_cvt_pk_bf16_f32 v176, v64, v65
    v_cvt_pk_bf16_f32 v177, v66, v67
    v_cvt_pk_bf16_f32 v178, v68, v69
    v_cvt_pk_bf16_f32 v179, v70, v71
    v_cvt_pk_bf16_f32 v180, v72, v73
    v_cvt_pk_bf16_f32 v181, v74, v75
    v_cvt_pk_bf16_f32 v182, v76, v77
    v_cvt_pk_bf16_f32 v183, v78, v79
    v_cvt_pk_bf16_f32 v200, v80, v81
    v_cvt_pk_bf16_f32 v201, v82, v83
    v_cvt_pk_bf16_f32 v202, v84, v85
    v_cvt_pk_bf16_f32 v203, v86, v87
    v_cvt_pk_bf16_f32 v204, v88, v89
    v_cvt_pk_bf16_f32 v205, v90, v91
    v_cvt_pk_bf16_f32 v206, v92, v93
    v_cvt_pk_bf16_f32 v207, v94, v95
    s_lshl_b32 s28, s25, 3
    s_add_u32 s28, s28, s23
    s_lshl_b32 s28, s28, 3
    s_add_u32 s28, s28, s20
    s_lshl_b32 s28, s28, 13
    v_add_u32 v10, s28, v7
    s_movk_i32 s29, 4096
    buffer_store_dwordx4 v[128:131], v10, s[40:43], 0 offen offset:0
    buffer_store_dwordx4 v[132:135], v10, s[40:43], 0 offen offset:1024
    buffer_store_dwordx4 v[152:155], v10, s[40:43], 0 offen offset:2048
    buffer_store_dwordx4 v[156:159], v10, s[40:43], 0 offen offset:3072
    buffer_store_dwordx4 v[176:179], v10, s[40:43], s29 offen offset:0
    buffer_store_dwordx4 v[180:183], v10, s[40:43], s29 offen offset:1024
    buffer_store_dwordx4 v[200:203], v10, s[40:43], s29 offen offset:2048
    buffer_store_dwordx4 v[204:207], v10, s[40:43], s29 offen offset:3072
    s_branch g1_fin
g1_w1:
    s_mul_i32 s28, s22, 7
    s_add_u32 s28, s28, 0
    v_xor_b32 v7, s28, v6
    v_lshl_add_u32 v18, v7, 5, v5
    s_mul_i32 s28, s22, 7
    s_add_u32 s28, s28, 1
    v_xor_b32 v7, s28, v6
    v_lshl_add_u32 v19, v7, 5, v5
    s_mul_i32 s28, s22, 7
    s_add_u32 s28, s28, 2
    v_xor_b32 v7, s28, v6
    v_lshl_add_u32 v20, v7, 5, v5
    s_mul_i32 s28, s22, 7
    s_add_u32 s28, s28, 3
    v_xor_b32 v7, s28, v6
    v_lshl_add_u32 v21, v7, 5, v5
    s_mul_i32 s28, s22, 7
    s_add_u32 s28, s28, 4
    v_xor_b32 v7, s28, v6
    v_lshl_add_u32 v22, v7, 5, v5
    s_mul_i32 s28, s22, 7
    s_add_u32 s28, s28, 5
    v_xor_b32 v7, s28, v6
    v_lshl_add_u32 v23, v7, 5, v5
    s_mul_i32 s28, s22, 7
    s_add_u32 s28, s28, 6
    v_xor_b32 v7, s28, v6
    v_lshl_add_u32 v24, v7, 5, v5
    s_mov_b32 s12, s30
    s_mov_b32 s13, s31
    s_and_b32 s13, s13, 0xffff
    s_mov_b32 s14, 0x700000
    s_mov_b32 s15, 0x00020000
    v_lshrrev_b32 v25, 5, v1
    v_add_u32 v25, 0, v25
    s_bfe_u32 s28, s20, 0x10001
    s_lshl_b32 s28, s28, 2
    v_or_b32 v26, s28, v25
    v_lshlrev_b32 v26, 1, v26
    v_and_b32 v27, 31, v1
    v_xor_b32 v26, v26, v27
    s_lshl_b32 s28, s20, 2
    v_add_u32 v25, s28, v25
    s_mul_i32 s28, s25, 448
    v_lshlrev_b32 v28, 4, v26
    v_add_u32 v28, s28, v28
    s_movk_i32 s28, 7168
    v_mul_lo_u32 v29, v25, s28
    v_add_u32 v28, v28, v29
    v_cmp_gt_u32 vcc, 28, v26
    v_mov_b32 v29, 0x7f000000
    s_nop 0
    v_cndmask_b32 v12, v29, v28, vcc
    v_lshrrev_b32 v25, 5, v1
    v_add_u32 v25, 2, v25
    s_bfe_u32 s28, s20, 0x10001
    s_lshl_b32 s28, s28, 2
    v_or_b32 v26, s28, v25
    v_lshlrev_b32 v26, 1, v26
    v_and_b32 v27, 31, v1
    v_xor_b32 v26, v26, v27
    s_lshl_b32 s28, s20, 2
    v_add_u32 v25, s28, v25
    s_mul_i32 s28, s25, 448
    v_lshlrev_b32 v28, 4, v26
    v_add_u32 v28, s28, v28
    s_movk_i32 s28, 7168
    v_mul_lo_u32 v29, v25, s28
    v_add_u32 v28, v28, v29
    v_cmp_gt_u32 vcc, 28, v26
    v_mov_b32 v29, 0x7f000000
    s_nop 0
    v_cndmask_b32 v13, v29, v28, vcc
    s_add_u32 m0, s27, 65536
    s_nop 0
    buffer_load_dwordx4 v12, s[12:15], s17 offen lds
    s_add_u32 m0, s27, 66560
    s_nop 0
    buffer_load_dwordx4 v13, s[12:15], s17 offen lds
    s_add_u32 s17, s17, 229376
    s_add_u32 m0, s27, 81920
    s_nop 0
    buffer_load_dwordx4 v12, s[12:15], s17 offen lds
    s_add_u32 m0, s27, 82944
    s_nop 0
    buffer_load_dwordx4 v13, s[12:15], s17 offen lds
    s_add_u32 s17, s17, 229376
    s_add_u32 m0, s27, 98304
    s_nop 0
    buffer_load_dwordx4 v12, s[12:15], s17 offen lds
    s_add_u32 m0, s27, 99328
    s_nop 0
    buffer_load_dwordx4 v13, s[12:15], s17 offen lds
    s_add_u32 s17, s17, 229376
    s_add_u32 m0, s27, 114688
    s_nop 0
    buffer_load_dwordx4 v12, s[12:15], s17 offen lds
    s_add_u32 m0, s27, 115712
    s_nop 0
    buffer_load_dwordx4 v13, s[12:15], s17 offen lds
    s_add_u32 s17, s17, 229376
    s_cmp_lg_u32 s20, 0
    s_cbranch_scc1 g1w_lnbar
    s_mov_b32 s29, 0
g1w_lnspin:
    buffer_load_dword v28, v11, s[52:55], 0 offen sc1
    s_waitcnt vmcnt(0)
    v_readfirstlane_b32 s28, v28
    s_add_u32 s29, s29, 1
    s_cmp_ge_u32 s28, 32
    s_cbranch_scc1 g1w_lnbar
    s_sleep 4
    s_cmp_lt_u32 s29, 0x100000
    s_cbranch_scc1 g1w_lnspin
g1w_lnbar:
    s_barrier
    s_add_u32 m0, s27, 0
    s_nop 0
    buffer_load_dwordx4 v8, s[8:11], s16 offen sc1 lds
    s_add_u32 m0, s27, 1024
    s_nop 0
    buffer_load_dwordx4 v9, s[8:11], s16 offen sc1 lds
    s_add_u32 s16, s16, 64
    s_add_u32 m0, s27, 16384
    s_nop 0
    buffer_load_dwordx4 v8, s[8:11], s16 offen sc1 lds
    s_add_u32 m0, s27, 17408
    s_nop 0
    buffer_load_dwordx4 v9, s[8:11], s16 offen sc1 lds
    s_add_u32 s16, s16, 64
    s_add_u32 m0, s27, 32768
    s_nop 0
    buffer_load_dwordx4 v8, s[8:11], s16 offen sc1 lds
    s_add_u32 m0, s27, 33792
    s_nop 0
    buffer_load_dwordx4 v9, s[8:11], s16 offen sc1 lds
    s_add_u32 s16, s16, 64
    s_add_u32 m0, s27, 49152
    s_nop 0
    buffer_load_dwordx4 v8, s[8:11], s16 offen sc1 lds
    s_add_u32 m0, s27, 50176
    s_nop 0
    buffer_load_dwordx4 v9, s[8:11], s16 offen sc1 lds
    s_add_u32 s16, s16, 64
    v_mov_b32 v128, 0
    v_mov_b32 v129, 0
    v_mov_b32 v130, 0
    v_mov_b32 v131, 0
    v_mov_b32 v132, 0
    v_mov_b32 v133, 0
    v_mov_b32 v134, 0
    v_mov_b32 v135, 0
    v_mov_b32 v136, 0
    v_mov_b32 v137, 0
    v_mov_b32 v138, 0
    v_mov_b32 v139, 0
    v_mov_b32 v140, 0
    v_mov_b32 v141, 0
    v_mov_b32 v142, 0
    v_mov_b32 v143, 0
    v_mov_b32 v144, 0
    v_mov_b32 v145, 0
    v_mov_b32 v146, 0
    v_mov_b32 v147, 0
    v_mov_b32 v148, 0
    v_mov_b32 v149, 0
    v_mov_b32 v150, 0
    v_mov_b32 v151, 0
    v_mov_b32 v152, 0
    v_mov_b32 v153, 0
    v_mov_b32 v154, 0
    v_mov_b32 v155, 0
    v_mov_b32 v156, 0
    v_mov_b32 v157, 0
    v_mov_b32 v158, 0
    v_mov_b32 v159, 0
    v_mov_b32 v160, 0
    v_mov_b32 v161, 0
    v_mov_b32 v162, 0
    v_mov_b32 v163, 0
    v_mov_b32 v164, 0
    v_mov_b32 v165, 0
    v_mov_b32 v166, 0
    v_mov_b32 v167, 0
    v_mov_b32 v168, 0
    v_mov_b32 v169, 0
    v_mov_b32 v170, 0
    v_mov_b32 v171, 0
    v_mov_b32 v172, 0
    v_mov_b32 v173, 0
    v_mov_b32 v174, 0
    v_mov_b32 v175, 0
    v_mov_b32 v176, 0
    v_mov_b32 v177, 0
    v_mov_b32 v178, 0
    v_mov_b32 v179, 0
    v_mov_b32 v180, 0
    v_mov_b32 v181, 0
    v_mov_b32 v182, 0
    v_mov_b32 v183, 0
    v_mov_b32 v184, 0
    v_mov_b32 v185, 0
    v_mov_b32 v186, 0
    v_mov_b32 v187, 0
    v_mov_b32 v188, 0
    v_mov_b32 v189, 0
    v_mov_b32 v190, 0
    v_mov_b32 v191, 0
    v_mov_b32 v192, 0
    v_mov_b32 v193, 0
    v_mov_b32 v194, 0
    v_mov_b32 v195, 0
    v_mov_b32 v196, 0
    v_mov_b32 v197, 0
    v_mov_b32 v198, 0
    v_mov_b32 v199, 0
    v_mov_b32 v200, 0
    v_mov_b32 v201, 0
    v_mov_b32 v202, 0
    v_mov_b32 v203, 0
    v_mov_b32 v204, 0
    v_mov_b32 v205, 0
    v_mov_b32 v206, 0
    v_mov_b32 v207, 0
    v_mov_b32 v208, 0
    v_mov_b32 v209, 0
    v_mov_b32 v210, 0
    v_mov_b32 v211, 0
    v_mov_b32 v212, 0
    v_mov_b32 v213, 0
    v_mov_b32 v214, 0
    v_mov_b32 v215, 0
    v_mov_b32 v216, 0
    v_mov_b32 v217, 0
    v_mov_b32 v218, 0
    v_mov_b32 v219, 0
    v_mov_b32 v220, 0
    v_mov_b32 v221, 0
    v_mov_b32 v222, 0
    v_mov_b32 v223, 0
    v_mov_b32 v224, 0
    v_mov_b32 v225, 0
    v_mov_b32 v226, 0
    v_mov_b32 v227, 0
    v_mov_b32 v228, 0
    v_mov_b32 v229, 0
    v_mov_b32 v230, 0
    v_mov_b32 v231, 0
    v_mov_b32 v232, 0
    v_mov_b32 v233, 0
    v_mov_b32 v234, 0
    v_mov_b32 v235, 0
    v_mov_b32 v236, 0
    v_mov_b32 v237, 0
    v_mov_b32 v238, 0
    v_mov_b32 v239, 0
    s_waitcnt vmcnt(0)
    s_barrier
    ds_read_b128 v[32:35], v16 offset:0
    ds_read_b128 v[36:39], v16 offset:1024
    ds_read_b128 v[40:43], v16 offset:2048
    ds_read_b128 v[44:47], v16 offset:3072
    ds_read_b64_tr_b16 v[48:49], v18 offset:0
    ds_read_b64_tr_b16 v[50:51], v18 offset:2048
    ds_read_b64_tr_b16 v[52:53], v19 offset:0
    ds_read_b64_tr_b16 v[54:55], v19 offset:2048
    ds_read_b64_tr_b16 v[56:57], v20 offset:0
    ds_read_b64_tr_b16 v[58:59], v20 offset:2048
    ds_read_b64_tr_b16 v[60:61], v21 offset:0
    ds_read_b64_tr_b16 v[62:63], v21 offset:2048
    ds_read_b64_tr_b16 v[64:65], v22 offset:0
    ds_read_b64_tr_b16 v[66:67], v22 offset:2048
    ds_read_b64_tr_b16 v[68:69], v23 offset:0
    ds_read_b64_tr_b16 v[70:71], v23 offset:2048
    ds_read_b64_tr_b16 v[72:73], v24 offset:0
    ds_read_b64_tr_b16 v[74:75], v24 offset:2048
    s_waitcnt lgkmcnt(0)
    s_barrier
    s_mov_b32 s18, 7
g1w_loop:
    v_mfma_f32_16x16x32_bf16 v[128:131], v[48:51], v[32:35], v[128:131]
    ds_read_b128 v[76:79], v16 offset:16384
    v_mfma_f32_16x16x32_bf16 v[132:135], v[52:55], v[32:35], v[132:135]
    s_add_u32 m0, s27, 0
    s_nop 0
    buffer_load_dwordx4 v8, s[8:11], s16 offen sc1 lds
    v_mfma_f32_16x16x32_bf16 v[136:139], v[56:59], v[32:35], v[136:139]
    ds_read_b128 v[80:83], v16 offset:17408
    v_mfma_f32_16x16x32_bf16 v[140:143], v[60:63], v[32:35], v[140:143]
    ds_read_b128 v[84:87], v16 offset:18432
    v_mfma_f32_16x16x32_bf16 v[144:147], v[64:67], v[32:35], v[144:147]
    ds_read_b128 v[88:91], v16 offset:19456
    v_mfma_f32_16x16x32_bf16 v[148:151], v[68:71], v[32:35], v[148:151]
    ds_read_b64_tr_b16 v[92:93], v18 offset:16384
    v_mfma_f32_16x16x32_bf16 v[152:155], v[72:75], v[32:35], v[152:155]
    ds_read_b64_tr_b16 v[94:95], v18 offset:18432
    v_mfma_f32_16x16x32_bf16 v[156:159], v[48:51], v[36:39], v[156:159]
    s_add_u32 m0, s27, 1024
    s_nop 0
    buffer_load_dwordx4 v9, s[8:11], s16 offen sc1 lds
    v_mfma_f32_16x16x32_bf16 v[160:163], v[52:55], v[36:39], v[160:163]
    ds_read_b64_tr_b16 v[96:97], v19 offset:16384
    v_mfma_f32_16x16x32_bf16 v[164:167], v[56:59], v[36:39], v[164:167]
    ds_read_b64_tr_b16 v[98:99], v19 offset:18432
    v_mfma_f32_16x16x32_bf16 v[168:171], v[60:63], v[36:39], v[168:171]
    ds_read_b64_tr_b16 v[100:101], v20 offset:16384
    v_mfma_f32_16x16x32_bf16 v[172:175], v[64:67], v[36:39], v[172:175]
    ds_read_b64_tr_b16 v[102:103], v20 offset:18432
    v_mfma_f32_16x16x32_bf16 v[176:179], v[68:71], v[36:39], v[176:179]
    ds_read_b64_tr_b16 v[104:105], v21 offset:16384
    v_mfma_f32_16x16x32_bf16 v[180:183], v[72:75], v[36:39], v[180:183]
    ds_read_b64_tr_b16 v[106:107], v21 offset:18432
    v_mfma_f32_16x16x32_bf16 v[184:187], v[48:51], v[40:43], v[184:187]
    s_add_u32 m0, s27, 65536
    s_nop 0
    buffer_load_dwordx4 v12, s[12:15], s17 offen lds
    v_mfma_f32_16x16x32_bf16 v[188:191], v[52:55], v[40:43], v[188:191]
    ds_read_b64_tr_b16 v[108:109], v22 offset:16384
    v_mfma_f32_16x16x32_bf16 v[192:195], v[56:59], v[40:43], v[192:195]
    ds_read_b64_tr_b16 v[110:111], v22 offset:18432
    v_mfma_f32_16x16x32_bf16 v[196:199], v[60:63], v[40:43], v[196:199]
    ds_read_b64_tr_b16 v[112:113], v23 offset:16384
    v_mfma_f32_16x16x32_bf16 v[200:203], v[64:67], v[40:43], v[200:203]
    ds_read_b64_tr_b16 v[114:115], v23 offset:18432
    v_mfma_f32_16x16x32_bf16 v[204:207], v[68:71], v[40:43], v[204:207]
    ds_read_b64_tr_b16 v[116:117], v24 offset:16384
    v_mfma_f32_16x16x32_bf16 v[208:211], v[72:75], v[40:43], v[208:211]
    s_add_u32 m0, s27, 66560
    s_nop 0
    buffer_load_dwordx4 v13, s[12:15], s17 offen lds
    s_add_u32 s16, s16, 64
    s_add_u32 s17, s17, 229376
    v_mfma_f32_16x16x32_bf16 v[212:215], v[48:51], v[44:47], v[212:215]
    ds_read_b64_tr_b16 v[118:119], v24 offset:18432
    v_mfma_f32_16x16x32_bf16 v[216:219], v[52:55], v[44:47], v[216:219]
    v_mfma_f32_16x16x32_bf16 v[220:223], v[56:59], v[44:47], v[220:223]
    v_mfma_f32_16x16x32_bf16 v[224:227], v[60:63], v[44:47], v[224:227]
    v_mfma_f32_16x16x32_bf16 v[228:231], v[64:67], v[44:47], v[228:231]
    v_mfma_f32_16x16x32_bf16 v[232:235], v[68:71], v[44:47], v[232:235]
    v_mfma_f32_16x16x32_bf16 v[236:239], v[72:75], v[44:47], v[236:239]
    s_waitcnt vmcnt(8) lgkmcnt(0)
    s_barrier
    v_mfma_f32_16x16x32_bf16 v[128:131], v[92:95], v[76:79], v[128:131]
    ds_read_b128 v[32:35], v16 offset:32768
    v_mfma_f32_16x16x32_bf16 v[132:135], v[96:99], v[76:79], v[132:135]
    s_add_u32 m0, s27, 16384
    s_nop 0
    buffer_load_dwordx4 v8, s[8:11], s16 offen sc1 lds
    v_mfma_f32_16x16x32_bf16 v[136:139], v[100:103], v[76:79], v[136:139]
    ds_read_b128 v[36:39], v16 offset:33792
    v_mfma_f32_16x16x32_bf16 v[140:143], v[104:107], v[76:79], v[140:143]
    ds_read_b128 v[40:43], v16 offset:34816
    v_mfma_f32_16x16x32_bf16 v[144:147], v[108:111], v[76:79], v[144:147]
    ds_read_b128 v[44:47], v16 offset:35840
    v_mfma_f32_16x16x32_bf16 v[148:151], v[112:115], v[76:79], v[148:151]
    ds_read_b64_tr_b16 v[48:49], v18 offset:32768
    v_mfma_f32_16x16x32_bf16 v[152:155], v[116:119], v[76:79], v[152:155]
    ds_read_b64_tr_b16 v[50:51], v18 offset:34816
    v_mfma_f32_16x16x32_bf16 v[156:159], v[92:95], v[80:83], v[156:159]
    s_add_u32 m0, s27, 17408
    s_nop 0
    buffer_load_dwordx4 v9, s[8:11], s16 offen sc1 lds
    v_mfma_f32_16x16x32_bf16 v[160:163], v[96:99], v[80:83], v[160:163]
    ds_read_b64_tr_b16 v[52:53], v19 offset:32768
    v_mfma_f32_16x16x32_bf16 v[164:167], v[100:103], v[80:83], v[164:167]
    ds_read_b64_tr_b16 v[54:55], v19 offset:34816
    v_mfma_f32_16x16x32_bf16 v[168:171], v[104:107], v[80:83], v[168:171]
    ds_read_b64_tr_b16 v[56:57], v20 offset:32768
    v_mfma_f32_16x16x32_bf16 v[172:175], v[108:111], v[80:83], v[172:175]
    ds_read_b64_tr_b16 v[58:59], v20 offset:34816
    v_mfma_f32_16x16x32_bf16 v[176:179], v[112:115], v[80:83], v[176:179]
    ds_read_b64_tr_b16 v[60:61], v21 offset:32768
    v_mfma_f32_16x16x32_bf16 v[180:183], v[116:119], v[80:83], v[180:183]
    ds_read_b64_tr_b16 v[62:63], v21 offset:34816
    v_mfma_f32_16x16x32_bf16 v[184:187], v[92:95], v[84:87], v[184:187]
    s_add_u32 m0, s27, 81920
    s_nop 0
    buffer_load_dwordx4 v12, s[12:15], s17 offen lds
    v_mfma_f32_16x16x32_bf16 v[188:191], v[96:99], v[84:87], v[188:191]
    ds_read_b64_tr_b16 v[64:65], v22 offset:32768
    v_mfma_f32_16x16x32_bf16 v[192:195], v[100:103], v[84:87], v[192:195]
    ds_read_b64_tr_b16 v[66:67], v22 offset:34816
    v_mfma_f32_16x16x32_bf16 v[196:199], v[104:107], v[84:87], v[196:199]
    ds_read_b64_tr_b16 v[68:69], v23 offset:32768
    v_mfma_f32_16x16x32_bf16 v[200:203], v[108:111], v[84:87], v[200:203]
    ds_read_b64_tr_b16 v[70:71], v23 offset:34816
    v_mfma_f32_16x16x32_bf16 v[204:207], v[112:115], v[84:87], v[204:207]
    ds_read_b64_tr_b16 v[72:73], v24 offset:32768
    v_mfma_f32_16x16x32_bf16 v[208:211], v[116:119], v[84:87], v[208:211]
    s_add_u32 m0, s27, 82944
    s_nop 0
    buffer_load_dwordx4 v13, s[12:15], s17 offen lds
    s_add_u32 s16, s16, 64
    s_add_u32 s17, s17, 229376
    v_mfma_f32_16x16x32_bf16 v[212:215], v[92:95], v[88:91], v[212:215]
    ds_read_b64_tr_b16 v[74:75], v24 offset:34816
    v_mfma_f32_16x16x32_bf16 v[216:219], v[96:99], v[88:91], v[216:219]
    v_mfma_f32_16x16x32_bf16 v[220:223], v[100:103], v[88:91], v[220:223]
    v_mfma_f32_16x16x32_bf16 v[224:227], v[104:107], v[88:91], v[224:227]
    v_mfma_f32_16x16x32_bf16 v[228:231], v[108:111], v[88:91], v[228:231]
    v_mfma_f32_16x16x32_bf16 v[232:235], v[112:115], v[88:91], v[232:235]
    v_mfma_f32_16x16x32_bf16 v[236:239], v[116:119], v[88:91], v[236:239]
    s_waitcnt vmcnt(8) lgkmcnt(0)
    s_barrier
    v_mfma_f32_16x16x32_bf16 v[128:131], v[48:51], v[32:35], v[128:131]
    ds_read_b128 v[76:79], v16 offset:49152
    v_mfma_f32_16x16x32_bf16 v[132:135], v[52:55], v[32:35], v[132:135]
    s_add_u32 m0, s27, 32768
    s_nop 0
    buffer_load_dwordx4 v8, s[8:11], s16 offen sc1 lds
    v_mfma_f32_16x16x32_bf16 v[136:139], v[56:59], v[32:35], v[136:139]
    ds_read_b128 v[80:83], v16 offset:50176
    v_mfma_f32_16x16x32_bf16 v[140:143], v[60:63], v[32:35], v[140:143]
    ds_read_b128 v[84:87], v16 offset:51200
    v_mfma_f32_16x16x32_bf16 v[144:147], v[64:67], v[32:35], v[144:147]
    ds_read_b128 v[88:91], v16 offset:52224
    v_mfma_f32_16x16x32_bf16 v[148:151], v[68:71], v[32:35], v[148:151]
    ds_read_b64_tr_b16 v[92:93], v18 offset:49152
    v_mfma_f32_16x16x32_bf16 v[152:155], v[72:75], v[32:35], v[152:155]
    ds_read_b64_tr_b16 v[94:95], v18 offset:51200
    v_mfma_f32_16x16x32_bf16 v[156:159], v[48:51], v[36:39], v[156:159]
    s_add_u32 m0, s27, 33792
    s_nop 0
    buffer_load_dwordx4 v9, s[8:11], s16 offen sc1 lds
    v_mfma_f32_16x16x32_bf16 v[160:163], v[52:55], v[36:39], v[160:163]
    ds_read_b64_tr_b16 v[96:97], v19 offset:49152
    v_mfma_f32_16x16x32_bf16 v[164:167], v[56:59], v[36:39], v[164:167]
    ds_read_b64_tr_b16 v[98:99], v19 offset:51200
    v_mfma_f32_16x16x32_bf16 v[168:171], v[60:63], v[36:39], v[168:171]
    ds_read_b64_tr_b16 v[100:101], v20 offset:49152
    v_mfma_f32_16x16x32_bf16 v[172:175], v[64:67], v[36:39], v[172:175]
    ds_read_b64_tr_b16 v[102:103], v20 offset:51200
    v_mfma_f32_16x16x32_bf16 v[176:179], v[68:71], v[36:39], v[176:179]
    ds_read_b64_tr_b16 v[104:105], v21 offset:49152
    v_mfma_f32_16x16x32_bf16 v[180:183], v[72:75], v[36:39], v[180:183]
    ds_read_b64_tr_b16 v[106:107], v21 offset:51200
    v_mfma_f32_16x16x32_bf16 v[184:187], v[48:51], v[40:43], v[184:187]
    s_add_u32 m0, s27, 98304
    s_nop 0
    buffer_load_dwordx4 v12, s[12:15], s17 offen lds
    v_mfma_f32_16x16x32_bf16 v[188:191], v[52:55], v[40:43], v[188:191]
    ds_read_b64_tr_b16 v[108:109], v22 offset:49152
    v_mfma_f32_16x16x32_bf16 v[192:195], v[56:59], v[40:43], v[192:195]
    ds_read_b64_tr_b16 v[110:111], v22 offset:51200
    v_mfma_f32_16x16x32_bf16 v[196:199], v[60:63], v[40:43], v[196:199]
    ds_read_b64_tr_b16 v[112:113], v23 offset:49152
    v_mfma_f32_16x16x32_bf16 v[200:203], v[64:67], v[40:43], v[200:203]
    ds_read_b64_tr_b16 v[114:115], v23 offset:51200
    v_mfma_f32_16x16x32_bf16 v[204:207], v[68:71], v[40:43], v[204:207]
    ds_read_b64_tr_b16 v[116:117], v24 offset:49152
    v_mfma_f32_16x16x32_bf16 v[208:211], v[72:75], v[40:43], v[208:211]
    s_add_u32 m0, s27, 99328
    s_nop 0
    buffer_load_dwordx4 v13, s[12:15], s17 offen lds
    s_add_u32 s16, s16, 64
    s_add_u32 s17, s17, 229376
    v_mfma_f32_16x16x32_bf16 v[212:215], v[48:51], v[44:47], v[212:215]
    ds_read_b64_tr_b16 v[118:119], v24 offset:51200
    v_mfma_f32_16x16x32_bf16 v[216:219], v[52:55], v[44:47], v[216:219]
    v_mfma_f32_16x16x32_bf16 v[220:223], v[56:59], v[44:47], v[220:223]
    v_mfma_f32_16x16x32_bf16 v[224:227], v[60:63], v[44:47], v[224:227]
    v_mfma_f32_16x16x32_bf16 v[228:231], v[64:67], v[44:47], v[228:231]
    v_mfma_f32_16x16x32_bf16 v[232:235], v[68:71], v[44:47], v[232:235]
    v_mfma_f32_16x16x32_bf16 v[236:239], v[72:75], v[44:47], v[236:239]
    s_waitcnt vmcnt(8) lgkmcnt(0)
    s_barrier
    v_mfma_f32_16x16x32_bf16 v[128:131], v[92:95], v[76:79], v[128:131]
    ds_read_b128 v[32:35], v16 offset:0
    v_mfma_f32_16x16x32_bf16 v[132:135], v[96:99], v[76:79], v[132:135]
    s_add_u32 m0, s27, 49152
    s_nop 0
    buffer_load_dwordx4 v8, s[8:11], s16 offen sc1 lds
    v_mfma_f32_16x16x32_bf16 v[136:139], v[100:103], v[76:79], v[136:139]
    ds_read_b128 v[36:39], v16 offset:1024
    v_mfma_f32_16x16x32_bf16 v[140:143], v[104:107], v[76:79], v[140:143]
    ds_read_b128 v[40:43], v16 offset:2048
    v_mfma_f32_16x16x32_bf16 v[144:147], v[108:111], v[76:79], v[144:147]
    ds_read_b128 v[44:47], v16 offset:3072
    v_mfma_f32_16x16x32_bf16 v[148:151], v[112:115], v[76:79], v[148:151]
    ds_read_b64_tr_b16 v[48:49], v18 offset:0
    v_mfma_f32_16x16x32_bf16 v[152:155], v[116:119], v[76:79], v[152:155]
    ds_read_b64_tr_b16 v[50:51], v18 offset:2048
    v_mfma_f32_16x16x32_bf16 v[156:159], v[92:95], v[80:83], v[156:159]
    s_add_u32 m0, s27, 50176
    s_nop 0
    buffer_load_dwordx4 v9, s[8:11], s16 offen sc1 lds
    v_mfma_f32_16x16x32_bf16 v[160:163], v[96:99], v[80:83], v[160:163]
    ds_read_b64_tr_b16 v[52:53], v19 offset:0
    v_mfma_f32_16x16x32_bf16 v[164:167], v[100:103], v[80:83], v[164:167]
    ds_read_b64_tr_b16 v[54:55], v19 offset:2048
    v_mfma_f32_16x16x32_bf16 v[168:171], v[104:107], v[80:83], v[168:171]
    ds_read_b64_tr_b16 v[56:57], v20 offset:0
    v_mfma_f32_16x16x32_bf16 v[172:175], v[108:111], v[80:83], v[172:175]
    ds_read_b64_tr_b16 v[58:59], v20 offset:2048
    v_mfma_f32_16x16x32_bf16 v[176:179], v[112:115], v[80:83], v[176:179]
    ds_read_b64_tr_b16 v[60:61], v21 offset:0
    v_mfma_f32_16x16x32_bf16 v[180:183], v[116:119], v[80:83], v[180:183]
    ds_read_b64_tr_b16 v[62:63], v21 offset:2048
    v_mfma_f32_16x16x32_bf16 v[184:187], v[92:95], v[84:87], v[184:187]
    s_add_u32 m0, s27, 114688
    s_nop 0
    buffer_load_dwordx4 v12, s[12:15], s17 offen lds
    v_mfma_f32_16x16x32_bf16 v[188:191], v[96:99], v[84:87], v[188:191]
    ds_read_b64_tr_b16 v[64:65], v22 offset:0
    v_mfma_f32_16x16x32_bf16 v[192:195], v[100:103], v[84:87], v[192:195]
    ds_read_b64_tr_b16 v[66:67], v22 offset:2048
    v_mfma_f32_16x16x32_bf16 v[196:199], v[104:107], v[84:87], v[196:199]
    ds_read_b64_tr_b16 v[68:69], v23 offset:0
    v_mfma_f32_16x16x32_bf16 v[200:203], v[108:111], v[84:87], v[200:203]
    ds_read_b64_tr_b16 v[70:71], v23 offset:2048
    v_mfma_f32_16x16x32_bf16 v[204:207], v[112:115], v[84:87], v[204:207]
    ds_read_b64_tr_b16 v[72:73], v24 offset:0
    v_mfma_f32_16x16x32_bf16 v[208:211], v[116:119], v[84:87], v[208:211]
    s_add_u32 m0, s27, 115712
    s_nop 0
    buffer_load_dwordx4 v13, s[12:15], s17 offen lds
    s_add_u32 s16, s16, 64
    s_add_u32 s17, s17, 229376
    v_mfma_f32_16x16x32_bf16 v[212:215], v[92:95], v[88:91], v[212:215]
    ds_read_b64_tr_b16 v[74:75], v24 offset:2048
    v_mfma_f32_16x16x32_bf16 v[216:219], v[96:99], v[88:91], v[216:219]
    v_mfma_f32_16x16x32_bf16 v[220:223], v[100:103], v[88:91], v[220:223]
    v_mfma_f32_16x16x32_bf16 v[224:227], v[104:107], v[88:91], v[224:227]
    v_mfma_f32_16x16x32_bf16 v[228:231], v[108:111], v[88:91], v[228:231]
    v_mfma_f32_16x16x32_bf16 v[232:235], v[112:115], v[88:91], v[232:235]
    v_mfma_f32_16x16x32_bf16 v[236:239], v[116:119], v[88:91], v[236:239]
    s_waitcnt vmcnt(8) lgkmcnt(0)
    s_barrier
    s_sub_u32 s18, s18, 1
    s_cmp_lg_u32 s18, 0
    s_cbranch_scc1 g1w_loop
    s_mov_b32 s36, s34
    s_mov_b32 s37, s35
    s_and_b32 s37, s37, 0xffff
    s_mov_b32 s38, 0x1c00
    s_mov_b32 s39, 0x00020000
    s_mul_i32 s28, s25, 448
    s_mul_i32 s29, s22, 224
    s_add_u32 s28, s28, s29
    v_lshlrev_b32 v25, 3, v4
    v_add_u32 v25, s28, v25
    buffer_load_dwordx2 v[240:241], v25, s[36:39], 0 offen offset:0
    buffer_load_dwordx2 v[242:243], v25, s[36:39], 0 offen offset:32
    buffer_load_dwordx2 v[244:245], v25, s[36:39], 0 offen offset:64
    buffer_load_dwordx2 v[246:247], v25, s[36:39], 0 offen offset:96
    buffer_load_dwordx2 v[248:249], v25, s[36:39], 0 offen offset:128
    buffer_load_dwordx2 v[250:251], v25, s[36:39], 0 offen offset:160
    buffer_load_dwordx2 v[252:253], v25, s[36:39], 0 offen offset:192
    v_mfma_f32_16x16x32_bf16 v[128:131], v[48:51], v[32:35], v[128:131]
    ds_read_b128 v[76:79], v16 offset:16384
    v_mfma_f32_16x16x32_bf16 v[132:135], v[52:55], v[32:35], v[132:135]
    v_mfma_f32_16x16x32_bf16 v[136:139], v[56:59], v[32:35], v[136:139]
    ds_read_b128 v[80:83], v16 offset:17408
    v_mfma_f32_16x16x32_bf16 v[140:143], v[60:63], v[32:35], v[140:143]
    ds_read_b128 v[84:87], v16 offset:18432
    v_mfma_f32_16x16x32_bf16 v[144:147], v[64:67], v[32:35], v[144:147]
    ds_read_b128 v[88:91], v16 offset:19456
    v_mfma_f32_16x16x32_bf16 v[148:151], v[68:71], v[32:35], v[148:151]
    ds_read_b64_tr_b16 v[92:93], v18 offset:16384
    v_mfma_f32_16x16x32_bf16 v[152:155], v[72:75], v[32:35], v[152:155]
    ds_read_b64_tr_b16 v[94:95], v18 offset:18432
    v_mfma_f32_16x16x32_bf16 v[156:159], v[48:51], v[36:39], v[156:159]
    v_mfma_f32_16x16x32_bf16 v[160:163], v[52:55], v[36:39], v[160:163]
    ds_read_b64_tr_b16 v[96:97], v19 offset:16384
    v_mfma_f32_16x16x32_bf16 v[164:167], v[56:59], v[36:39], v[164:167]
    ds_read_b64_tr_b16 v[98:99], v19 offset:18432
    v_mfma_f32_16x16x32_bf16 v[168:171], v[60:63], v[36:39], v[168:171]
    ds_read_b64_tr_b16 v[100:101], v20 offset:16384
    v_mfma_f32_16x16x32_bf16 v[172:175], v[64:67], v[36:39], v[172:175]
    ds_read_b64_tr_b16 v[102:103], v20 offset:18432
    v_mfma_f32_16x16x32_bf16 v[176:179], v[68:71], v[36:39], v[176:179]
    ds_read_b64_tr_b16 v[104:105], v21 offset:16384
    v_mfma_f32_16x16x32_bf16 v[180:183], v[72:75], v[36:39], v[180:183]
    ds_read_b64_tr_b16 v[106:107], v21 offset:18432
    v_mfma_f32_16x16x32_bf16 v[184:187], v[48:51], v[40:43], v[184:187]
    v_mfma_f32_16x16x32_bf16 v[188:191], v[52:55], v[40:43], v[188:191]
    ds_read_b64_tr_b16 v[108:109], v22 offset:16384
    v_mfma_f32_16x16x32_bf16 v[192:195], v[56:59], v[40:43], v[192:195]
    ds_read_b64_tr_b16 v[110:111], v22 offset:18432
    v_mfma_f32_16x16x32_bf16 v[196:199], v[60:63], v[40:43], v[196:199]
    ds_read_b64_tr_b16 v[112:113], v23 offset:16384
    v_mfma_f32_16x16x32_bf16 v[200:203], v[64:67], v[40:43], v[200:203]
    ds_read_b64_tr_b16 v[114:115], v23 offset:18432
    v_mfma_f32_16x16x32_bf16 v[204:207], v[68:71], v[40:43], v[204:207]
    ds_read_b64_tr_b16 v[116:117], v24 offset:16384
    v_mfma_f32_16x16x32_bf16 v[208:211], v[72:75], v[40:43], v[208:211]
    v_mfma_f32_16x16x32_bf16 v[212:215], v[48:51], v[44:47], v[212:215]
    ds_read_b64_tr_b16 v[118:119], v24 offset:18432
    v_mfma_f32_16x16x32_bf16 v[216:219], v[52:55], v[44:47], v[216:219]
    v_mfma_f32_16x16x32_bf16 v[220:223], v[56:59], v[44:47], v[220:223]
    v_mfma_f32_16x16x32_bf16 v[224:227], v[60:63], v[44:47], v[224:227]
    v_mfma_f32_16x16x32_bf16 v[228:231], v[64:67], v[44:47], v[228:231]
    v_mfma_f32_16x16x32_bf16 v[232:235], v[68:71], v[44:47], v[232:235]
    v_mfma_f32_16x16x32_bf16 v[236:239], v[72:75], v[44:47], v[236:239]
    s_waitcnt vmcnt(11) lgkmcnt(0)
    s_barrier
    v_mfma_f32_16x16x32_bf16 v[128:131], v[92:95], v[76:79], v[128:131]
    ds_read_b128 v[32:35], v16 offset:32768
    v_mfma_f32_16x16x32_bf16 v[132:135], v[96:99], v[76:79], v[132:135]
    v_mfma_f32_16x16x32_bf16 v[136:139], v[100:103], v[76:79], v[136:139]
    ds_read_b128 v[36:39], v16 offset:33792
    v_mfma_f32_16x16x32_bf16 v[140:143], v[104:107], v[76:79], v[140:143]
    ds_read_b128 v[40:43], v16 offset:34816
    v_mfma_f32_16x16x32_bf16 v[144:147], v[108:111], v[76:79], v[144:147]
    ds_read_b128 v[44:47], v16 offset:35840
    v_mfma_f32_16x16x32_bf16 v[148:151], v[112:115], v[76:79], v[148:151]
    ds_read_b64_tr_b16 v[48:49], v18 offset:32768
    v_mfma_f32_16x16x32_bf16 v[152:155], v[116:119], v[76:79], v[152:155]
    ds_read_b64_tr_b16 v[50:51], v18 offset:34816
    v_mfma_f32_16x16x32_bf16 v[156:159], v[92:95], v[80:83], v[156:159]
    v_mfma_f32_16x16x32_bf16 v[160:163], v[96:99], v[80:83], v[160:163]
    ds_read_b64_tr_b16 v[52:53], v19 offset:32768
    v_mfma_f32_16x16x32_bf16 v[164:167], v[100:103], v[80:83], v[164:167]
    ds_read_b64_tr_b16 v[54:55], v19 offset:34816
    v_mfma_f32_16x16x32_bf16 v[168:171], v[104:107], v[80:83], v[168:171]
    ds_read_b64_tr_b16 v[56:57], v20 offset:32768
    v_mfma_f32_16x16x32_bf16 v[172:175], v[108:111], v[80:83], v[172:175]
    ds_read_b64_tr_b16 v[58:59], v20 offset:34816
    v_mfma_f32_16x16x32_bf16 v[176:179], v[112:115], v[80:83], v[176:179]
    ds_read_b64_tr_b16 v[60:61], v21 offset:32768
    v_mfma_f32_16x16x32_bf16 v[180:183], v[116:119], v[80:83], v[180:183]
    ds_read_b64_tr_b16 v[62:63], v21 offset:34816
    v_mfma_f32_16x16x32_bf16 v[184:187], v[92:95], v[84:87], v[184:187]
    v_mfma_f32_16x16x32_bf16 v[188:191], v[96:99], v[84:87], v[188:191]
    ds_read_b64_tr_b16 v[64:65], v22 offset:32768
    v_mfma_f32_16x16x32_bf16 v[192:195], v[100:103], v[84:87], v[192:195]
    ds_read_b64_tr_b16 v[66:67], v22 offset:34816
    v_mfma_f32_16x16x32_bf16 v[196:199], v[104:107], v[84:87], v[196:199]
    ds_read_b64_tr_b16 v[68:69], v23 offset:32768
    v_mfma_f32_16x16x32_bf16 v[200:203], v[108:111], v[84:87], v[200:203]
    ds_read_b64_tr_b16 v[70:71], v23 offset:34816
    v_mfma_f32_16x16x32_bf16 v[204:207], v[112:115], v[84:87], v[204:207]
    ds_read_b64_tr_b16 v[72:73], v24 offset:32768
    v_mfma_f32_16x16x32_bf16 v[208:211], v[116:119], v[84:87], v[208:211]
    v_mfma_f32_16x16x32_bf16 v[212:215], v[92:95], v[88:91], v[212:215]
    ds_read_b64_tr_b16 v[74:75], v24 offset:34816
    v_mfma_f32_16x16x32_bf16 v[216:219], v[96:99], v[88:91], v[216:219]
    v_mfma_f32_16x16x32_bf16 v[220:223], v[100:103], v[88:91], v[220:223]
    v_mfma_f32_16x16x32_bf16 v[224:227], v[104:107], v[88:91], v[224:227]
    v_mfma_f32_16x16x32_bf16 v[228:231], v[108:111], v[88:91], v[228:231]
    v_mfma_f32_16x16x32_bf16 v[232:235], v[112:115], v[88:91], v[232:235]
    v_mfma_f32_16x16x32_bf16 v[236:239], v[116:119], v[88:91], v[236:239]
    s_waitcnt vmcnt(7) lgkmcnt(0)
    s_barrier
    v_mfma_f32_16x16x32_bf16 v[128:131], v[48:51], v[32:35], v[128:131]
    ds_read_b128 v[76:79], v16 offset:49152
    v_mfma_f32_16x16x32_bf16 v[132:135], v[52:55], v[32:35], v[132:135]
    v_mfma_f32_16x16x32_bf16 v[136:139], v[56:59], v[32:35], v[136:139]
    ds_read_b128 v[80:83], v16 offset:50176
    v_mfma_f32_16x16x32_bf16 v[140:143], v[60:63], v[32:35], v[140:143]
    ds_read_b128 v[84:87], v16 offset:51200
    v_mfma_f32_16x16x32_bf16 v[144:147], v[64:67], v[32:35], v[144:147]
    ds_read_b128 v[88:91], v16 offset:52224
    v_mfma_f32_16x16x32_bf16 v[148:151], v[68:71], v[32:35], v[148:151]
    ds_read_b64_tr_b16 v[92:93], v18 offset:49152
    v_mfma_f32_16x16x32_bf16 v[152:155], v[72:75], v[32:35], v[152:155]
    ds_read_b64_tr_b16 v[94:95], v18 offset:51200
    v_mfma_f32_16x16x32_bf16 v[156:159], v[48:51], v[36:39], v[156:159]
    v_mfma_f32_16x16x32_bf16 v[160:163], v[52:55], v[36:39], v[160:163]
    ds_read_b64_tr_b16 v[96:97], v19 offset:49152
    v_mfma_f32_16x16x32_bf16 v[164:167], v[56:59], v[36:39], v[164:167]
    ds_read_b64_tr_b16 v[98:99], v19 offset:51200
    v_mfma_f32_16x16x32_bf16 v[168:171], v[60:63], v[36:39], v[168:171]
    ds_read_b64_tr_b16 v[100:101], v20 offset:49152
    v_mfma_f32_16x16x32_bf16 v[172:175], v[64:67], v[36:39], v[172:175]
    ds_read_b64_tr_b16 v[102:103], v20 offset:51200
    v_mfma_f32_16x16x32_bf16 v[176:179], v[68:71], v[36:39], v[176:179]
    ds_read_b64_tr_b16 v[104:105], v21 offset:49152
    v_mfma_f32_16x16x32_bf16 v[180:183], v[72:75], v[36:39], v[180:183]
    ds_read_b64_tr_b16 v[106:107], v21 offset:51200
    v_mfma_f32_16x16x32_bf16 v[184:187], v[48:51], v[40:43], v[184:187]
    v_mfma_f32_16x16x32_bf16 v[188:191], v[52:55], v[40:43], v[188:191]
    ds_read_b64_tr_b16 v[108:109], v22 offset:49152
    v_mfma_f32_16x16x32_bf16 v[192:195], v[56:59], v[40:43], v[192:195]
    ds_read_b64_tr_b16 v[110:111], v22 offset:51200
    v_mfma_f32_16x16x32_bf16 v[196:199], v[60:63], v[40:43], v[196:199]
    ds_read_b64_tr_b16 v[112:113], v23 offset:49152
    v_mfma_f32_16x16x32_bf16 v[200:203], v[64:67], v[40:43], v[200:203]
    ds_read_b64_tr_b16 v[114:115], v23 offset:51200
    v_mfma_f32_16x16x32_bf16 v[204:207], v[68:71], v[40:43], v[204:207]
    ds_read_b64_tr_b16 v[116:117], v24 offset:49152
    v_mfma_f32_16x16x32_bf16 v[208:211], v[72:75], v[40:43], v[208:211]
    v_mfma_f32_16x16x32_bf16 v[212:215], v[48:51], v[44:47], v[212:215]
    ds_read_b64_tr_b16 v[118:119], v24 offset:51200
    v_mfma_f32_16x16x32_bf16 v[216:219], v[52:55], v[44:47], v[216:219]
    v_mfma_f32_16x16x32_bf16 v[220:223], v[56:59], v[44:47], v[220:223]
    v_mfma_f32_16x16x32_bf16 v[224:227], v[60:63], v[44:47], v[224:227]
    v_mfma_f32_16x16x32_bf16 v[228:231], v[64:67], v[44:47], v[228:231]
    v_mfma_f32_16x16x32_bf16 v[232:235], v[68:71], v[44:47], v[232:235]
    v_mfma_f32_16x16x32_bf16 v[236:239], v[72:75], v[44:47], v[236:239]
    s_waitcnt lgkmcnt(0)
    s_barrier
    v_mfma_f32_16x16x32_bf16 v[128:131], v[92:95], v[76:79], v[128:131]
    v_mfma_f32_16x16x32_bf16 v[132:135], v[96:99], v[76:79], v[132:135]
    v_mfma_f32_16x16x32_bf16 v[136:139], v[100:103], v[76:79], v[136:139]
    v_mfma_f32_16x16x32_bf16 v[140:143], v[104:107], v[76:79], v[140:143]
    v_mfma_f32_16x16x32_bf16 v[144:147], v[108:111], v[76:79], v[144:147]
    v_mfma_f32_16x16x32_bf16 v[148:151], v[112:115], v[76:79], v[148:151]
    v_mfma_f32_16x16x32_bf16 v[152:155], v[116:119], v[76:79], v[152:155]
    v_mfma_f32_16x16x32_bf16 v[156:159], v[92:95], v[80:83], v[156:159]
    v_mfma_f32_16x16x32_bf16 v[160:163], v[96:99], v[80:83], v[160:163]
    v_mfma_f32_16x16x32_bf16 v[164:167], v[100:103], v[80:83], v[164:167]
    v_mfma_f32_16x16x32_bf16 v[168:171], v[104:107], v[80:83], v[168:171]
    v_mfma_f32_16x16x32_bf16 v[172:175], v[108:111], v[80:83], v[172:175]
    v_mfma_f32_16x16x32_bf16 v[176:179], v[112:115], v[80:83], v[176:179]
    v_mfma_f32_16x16x32_bf16 v[180:183], v[116:119], v[80:83], v[180:183]
    v_mfma_f32_16x16x32_bf16 v[184:187], v[92:95], v[84:87], v[184:187]
    v_mfma_f32_16x16x32_bf16 v[188:191], v[96:99], v[84:87], v[188:191]
    v_mfma_f32_16x16x32_bf16 v[192:195], v[100:103], v[84:87], v[192:195]
    v_mfma_f32_16x16x32_bf16 v[196:199], v[104:107], v[84:87], v[196:199]
    v_mfma_f32_16x16x32_bf16 v[200:203], v[108:111], v[84:87], v[200:203]
    v_mfma_f32_16x16x32_bf16 v[204:207], v[112:115], v[84:87], v[204:207]
    v_mfma_f32_16x16x32_bf16 v[208:211], v[116:119], v[84:87], v[208:211]
    v_mfma_f32_16x16x32_bf16 v[212:215], v[92:95], v[88:91], v[212:215]
    v_mfma_f32_16x16x32_bf16 v[216:219], v[96:99], v[88:91], v[216:219]
    v_mfma_f32_16x16x32_bf16 v[220:223], v[100:103], v[88:91], v[220:223]
    v_mfma_f32_16x16x32_bf16 v[224:227], v[104:107], v[88:91], v[224:227]
    v_mfma_f32_16x16x32_bf16 v[228:231], v[108:111], v[88:91], v[228:231]
    v_mfma_f32_16x16x32_bf16 v[232:235], v[112:115], v[88:91], v[232:235]
    v_mfma_f32_16x16x32_bf16 v[236:239], v[116:119], v[88:91], v[236:239]
    s_mov_b32 s40, s48
    s_mov_b32 s41, s49
    s_and_b32 s41, s41, 0xffff
    s_mov_b32 s42, 0x700000
    s_mov_b32 s43, 0x00020000
    buffer_load_dword v30, v31, s[40:43], 0 offen
    s_mov_b32 s40, s44
    s_mov_b32 s41, s45
    s_and_b32 s41, s41, 0xffff
    s_mov_b32 s42, 0x200000
    s_mov_b32 s43, 0x00020000
    buffer_load_dword v30, v31, s[40:43], 0 offen
    s_waitcnt vmcnt(2)
    s_add_u32 s40, s4, 0x400000
    s_addc_u32 s41, s5, 0
    s_and_b32 s41, s41, 0xffff
    s_mov_b32 s42, 0x1200000
    s_mov_b32 s43, 0x00020000
    v_lshlrev_b32 v32, 16, v240
    v_and_b32 v33, 0xffff0000, v240
    v_lshlrev_b32 v34, 16, v241
    v_and_b32 v35, 0xffff0000, v241
    v_lshlrev_b32 v36, 16, v242
    v_and_b32 v37, 0xffff0000, v242
    v_lshlrev_b32 v38, 16, v243
    v_and_b32 v39, 0xffff0000, v243
    v_lshlrev_b32 v40, 16, v244
    v_and_b32 v41, 0xffff0000, v244
    v_lshlrev_b32 v42, 16, v245
    v_and_b32 v43, 0xffff0000, v245
    v_lshlrev_b32 v44, 16, v246
    v_and_b32 v45, 0xffff0000, v246
    v_lshlrev_b32 v46, 16, v247
    v_and_b32 v47, 0xffff0000, v247
    v_lshlrev_b32 v48, 16, v248
    v_and_b32 v49, 0xffff0000, v248
    v_lshlrev_b32 v50, 16, v249
    v_and_b32 v51, 0xffff0000, v249
    v_lshlrev_b32 v52, 16, v250
    v_and_b32 v53, 0xffff0000, v250
    v_lshlrev_b32 v54, 16, v251
    v_and_b32 v55, 0xffff0000, v251
    v_lshlrev_b32 v56, 16, v252
    v_and_b32 v57, 0xffff0000, v252
    v_lshlrev_b32 v58, 16, v253
    v_and_b32 v59, 0xffff0000, v253
    s_mul_i32 s28, s20, 15360
    s_movk_i32 s29, 240
    v_mul_lo_u32 v6, v3, s29
    v_lshl_add_u32 v6, v4, 3, v6
    v_add_u32 v6, s28, v6
    v_subrev_u32 v7, 56, v1
    v_cmp_gt_u32 vcc, 56, v1
    s_nop 1
    v_cndmask_b32 v7, v7, v1, vcc
    v_mul_u32_u24 v8, 0x4a, v7
    v_lshrrev_b32 v8, 10, v8
    v_mul_u32_u24 v9, 14, v8
    v_sub_u32 v9, v7, v9
    v_mul_lo_u32 v7, v8, s29
    v_lshl_add_u32 v7, v9, 4, v7
    v_add_u32 v7, s28, v7
    s_lshl_b32 s28, s23, 8
    s_lshl_b32 s29, s21, 6
    s_add_u32 s28, s28, s29
    v_add_u32 v5, s28, v8
    s_movk_i32 s28, 9216
    v_mul_lo_u32 v5, v5, s28
    s_mul_i32 s28, s25, 448
    s_mul_i32 s29, s22, 224
    s_add_u32 s28, s28, s29
    v_lshl_add_u32 v9, v9, 4, s28
    v_add_u32 v5, v5, v9
    s_mov_b32 s44, 0xbdd2d3e8
    s_mov_b32 s45, 0xbdd2d3e8
    s_mov_b32 s46, 1.0
    s_mov_b32 s47, 1.0
    v_mov_b32 v8, 0xc0135761
    v_mov_b32 v9, 0xc0135761
    s_barrier
    v_pk_add_f32 v[64:65], v[128:129], v[32:33]
    v_pk_add_f32 v[66:67], v[130:131], v[34:35]
    v_pk_mul_f32 v[68:69], v[64:65], v[64:65]
    v_pk_mul_f32 v[70:71], v[66:67], v[66:67]
    v_pk_fma_f32 v[68:69], v[68:69], s[44:45], v[8:9]
    v_pk_fma_f32 v[70:71], v[70:71], s[44:45], v[8:9]
    v_pk_mul_f32 v[68:69], v[68:69], v[64:65]
    v_pk_mul_f32 v[70:71], v[70:71], v[66:67]
    v_exp_f32 v68, v68
    v_exp_f32 v69, v69
    v_exp_f32 v70, v70
    v_exp_f32 v71, v71
    s_nop 0
    v_pk_add_f32 v[68:69], v[68:69], s[46:47]
    v_pk_add_f32 v[70:71], v[70:71], s[46:47]
    v_rcp_f32 v68, v68
    v_rcp_f32 v69, v69
    v_rcp_f32 v70, v70
    v_rcp_f32 v71, v71
    s_nop 0
    v_pk_mul_f32 v[68:69], v[68:69], v[64:65]
    v_pk_mul_f32 v[70:71], v[70:71], v[66:67]
    v_cvt_pk_bf16_f32 v72, v68, v69
    v_cvt_pk_bf16_f32 v73, v70, v71
    ds_write_b64 v6, v[72:73] offset:0
    v_pk_add_f32 v[80:81], v[132:133], v[36:37]
    v_pk_add_f32 v[82:83], v[134:135], v[38:39]
    v_pk_mul_f32 v[84:85], v[80:81], v[80:81]
    v_pk_mul_f32 v[86:87], v[82:83], v[82:83]
    v_pk_fma_f32 v[84:85], v[84:85], s[44:45], v[8:9]
    v_pk_fma_f32 v[86:87], v[86:87], s[44:45], v[8:9]
    v_pk_mul_f32 v[84:85], v[84:85], v[80:81]
    v_pk_mul_f32 v[86:87], v[86:87], v[82:83]
    v_exp_f32 v84, v84
    v_exp_f32 v85, v85
    v_exp_f32 v86, v86
    v_exp_f32 v87, v87
    s_nop 0
    v_pk_add_f32 v[84:85], v[84:85], s[46:47]
    v_pk_add_f32 v[86:87], v[86:87], s[46:47]
    v_rcp_f32 v84, v84
    v_rcp_f32 v85, v85
    v_rcp_f32 v86, v86
    v_rcp_f32 v87, v87
    s_nop 0
    v_pk_mul_f32 v[84:85], v[84:85], v[80:81]
    v_pk_mul_f32 v[86:87], v[86:87], v[82:83]
    v_cvt_pk_bf16_f32 v88, v84, v85
    v_cvt_pk_bf16_f32 v89, v86, v87
    ds_write_b64 v6, v[88:89] offset:32
    v_pk_add_f32 v[64:65], v[136:137], v[40:41]
    v_pk_add_f32 v[66:67], v[138:139], v[42:43]
    v_pk_mul_f32 v[68:69], v[64:65], v[64:65]
    v_pk_mul_f32 v[70:71], v[66:67], v[66:67]
    v_pk_fma_f32 v[68:69], v[68:69], s[44:45], v[8:9]
    v_pk_fma_f32 v[70:71], v[70:71], s[44:45], v[8:9]
    v_pk_mul_f32 v[68:69], v[68:69], v[64:65]
    v_pk_mul_f32 v[70:71], v[70:71], v[66:67]
    v_exp_f32 v68, v68
    v_exp_f32 v69, v69
    v_exp_f32 v70, v70
    v_exp_f32 v71, v71
    s_nop 0
    v_pk_add_f32 v[68:69], v[68:69], s[46:47]
    v_pk_add_f32 v[70:71], v[70:71], s[46:47]
    v_rcp_f32 v68, v68
    v_rcp_f32 v69, v69
    v_rcp_f32 v70, v70
    v_rcp_f32 v71, v71
    s_nop 0
    v_pk_mul_f32 v[68:69], v[68:69], v[64:65]
    v_pk_mul_f32 v[70:71], v[70:71], v[66:67]
    v_cvt_pk_bf16_f32 v72, v68, v69
    v_cvt_pk_bf16_f32 v73, v70, v71
    ds_write_b64 v6, v[72:73] offset:64
    v_pk_add_f32 v[80:81], v[140:141], v[44:45]
    v_pk_add_f32 v[82:83], v[142:143], v[46:47]
    v_pk_mul_f32 v[84:85], v[80:81], v[80:81]
    v_pk_mul_f32 v[86:87], v[82:83], v[82:83]
    v_pk_fma_f32 v[84:85], v[84:85], s[44:45], v[8:9]
    v_pk_fma_f32 v[86:87], v[86:87], s[44:45], v[8:9]
    v_pk_mul_f32 v[84:85], v[84:85], v[80:81]
    v_pk_mul_f32 v[86:87], v[86:87], v[82:83]
    v_exp_f32 v84, v84
    v_exp_f32 v85, v85
    v_exp_f32 v86, v86
    v_exp_f32 v87, v87
    s_nop 0
    v_pk_add_f32 v[84:85], v[84:85], s[46:47]
    v_pk_add_f32 v[86:87], v[86:87], s[46:47]
    v_rcp_f32 v84, v84
    v_rcp_f32 v85, v85
    v_rcp_f32 v86, v86
    v_rcp_f32 v87, v87
    s_nop 0
    v_pk_mul_f32 v[84:85], v[84:85], v[80:81]
    v_pk_mul_f32 v[86:87], v[86:87], v[82:83]
    v_cvt_pk_bf16_f32 v88, v84, v85
    v_cvt_pk_bf16_f32 v89, v86, v87
    ds_write_b64 v6, v[88:89] offset:96
    v_pk_add_f32 v[64:65], v[144:145], v[48:49]
    v_pk_add_f32 v[66:67], v[146:147], v[50:51]
    v_pk_mul_f32 v[68:69], v[64:65], v[64:65]
    v_pk_mul_f32 v[70:71], v[66:67], v[66:67]
    v_pk_fma_f32 v[68:69], v[68:69], s[44:45], v[8:9]
    v_pk_fma_f32 v[70:71], v[70:71], s[44:45], v[8:9]
    v_pk_mul_f32 v[68:69], v[68:69], v[64:65]
    v_pk_mul_f32 v[70:71], v[70:71], v[66:67]
    v_exp_f32 v68, v68
    v_exp_f32 v69, v69
    v_exp_f32 v70, v70
    v_exp_f32 v71, v71
    s_nop 0
    v_pk_add_f32 v[68:69], v[68:69], s[46:47]
    v_pk_add_f32 v[70:71], v[70:71], s[46:47]
    v_rcp_f32 v68, v68
    v_rcp_f32 v69, v69
    v_rcp_f32 v70, v70
    v_rcp_f32 v71, v71
    s_nop 0
    v_pk_mul_f32 v[68:69], v[68:69], v[64:65]
    v_pk_mul_f32 v[70:71], v[70:71], v[66:67]
    v_cvt_pk_bf16_f32 v72, v68, v69
    v_cvt_pk_bf16_f32 v73, v70, v71
    ds_write_b64 v6, v[72:73] offset:128
    v_pk_add_f32 v[80:81], v[148:149], v[52:53]
    v_pk_add_f32 v[82:83], v[150:151], v[54:55]
    v_pk_mul_f32 v[84:85], v[80:81], v[80:81]
    v_pk_mul_f32 v[86:87], v[82:83], v[82:83]
    v_pk_fma_f32 v[84:85], v[84:85], s[44:45], v[8:9]
    v_pk_fma_f32 v[86:87], v[86:87], s[44:45], v[8:9]
    v_pk_mul_f32 v[84:85], v[84:85], v[80:81]
    v_pk_mul_f32 v[86:87], v[86:87], v[82:83]
    v_exp_f32 v84, v84
    v_exp_f32 v85, v85
    v_exp_f32 v86, v86
    v_exp_f32 v87, v87
    s_nop 0
    v_pk_add_f32 v[84:85], v[84:85], s[46:47]
    v_pk_add_f32 v[86:87], v[86:87], s[46:47]
    v_rcp_f32 v84, v84
    v_rcp_f32 v85, v85
    v_rcp_f32 v86, v86
    v_rcp_f32 v87, v87
    s_nop 0
    v_pk_mul_f32 v[84:85], v[84:85], v[80:81]
    v_pk_mul_f32 v[86:87], v[86:87], v[82:83]
    v_cvt_pk_bf16_f32 v88, v84, v85
    v_cvt_pk_bf16_f32 v89, v86, v87
    ds_write_b64 v6, v[88:89] offset:160
    v_pk_add_f32 v[64:65], v[152:153], v[56:57]
    v_pk_add_f32 v[66:67], v[154:155], v[58:59]
    v_pk_mul_f32 v[68:69], v[64:65], v[64:65]
    v_pk_mul_f32 v[70:71], v[66:67], v[66:67]
    v_pk_fma_f32 v[68:69], v[68:69], s[44:45], v[8:9]
    v_pk_fma_f32 v[70:71], v[70:71], s[44:45], v[8:9]
    v_pk_mul_f32 v[68:69], v[68:69], v[64:65]
    v_pk_mul_f32 v[70:71], v[70:71], v[66:67]
    v_exp_f32 v68, v68
    v_exp_f32 v69, v69
    v_exp_f32 v70, v70
    v_exp_f32 v71, v71
    s_nop 0
    v_pk_add_f32 v[68:69], v[68:69], s[46:47]
    v_pk_add_f32 v[70:71], v[70:71], s[46:47]
    v_rcp_f32 v68, v68
    v_rcp_f32 v69, v69
    v_rcp_f32 v70, v70
    v_rcp_f32 v71, v71
    s_nop 0
    v_pk_mul_f32 v[68:69], v[68:69], v[64:65]
    v_pk_mul_f32 v[70:71], v[70:71], v[66:67]
    v_cvt_pk_bf16_f32 v72, v68, v69
    v_cvt_pk_bf16_f32 v73, v70, v71
    ds_write_b64 v6, v[72:73] offset:192
    s_waitcnt lgkmcnt(0)
    v_pk_add_f32 v[80:81], v[156:157], v[32:33]
    v_pk_add_f32 v[82:83], v[158:159], v[34:35]
    v_pk_mul_f32 v[84:85], v[80:81], v[80:81]
    v_pk_mul_f32 v[86:87], v[82:83], v[82:83]
    v_pk_fma_f32 v[84:85], v[84:85], s[44:45], v[8:9]
    v_pk_fma_f32 v[86:87], v[86:87], s[44:45], v[8:9]
    v_pk_mul_f32 v[84:85], v[84:85], v[80:81]
    v_pk_mul_f32 v[86:87], v[86:87], v[82:83]
    v_exp_f32 v84, v84
    v_exp_f32 v85, v85
    v_exp_f32 v86, v86
    v_exp_f32 v87, v87
    s_nop 0
    v_pk_add_f32 v[84:85], v[84:85], s[46:47]
    v_pk_add_f32 v[86:87], v[86:87], s[46:47]
    v_rcp_f32 v84, v84
    v_rcp_f32 v85, v85
    v_rcp_f32 v86, v86
    v_rcp_f32 v87, v87
    s_nop 0
    v_pk_mul_f32 v[84:85], v[84:85], v[80:81]
    v_pk_mul_f32 v[86:87], v[86:87], v[82:83]
    v_cvt_pk_bf16_f32 v88, v84, v85
    v_cvt_pk_bf16_f32 v89, v86, v87
    ds_write_b64 v6, v[88:89] offset:3840
    v_pk_add_f32 v[64:65], v[160:161], v[36:37]
    v_pk_add_f32 v[66:67], v[162:163], v[38:39]
    v_pk_mul_f32 v[68:69], v[64:65], v[64:65]
    v_pk_mul_f32 v[70:71], v[66:67], v[66:67]
    v_pk_fma_f32 v[68:69], v[68:69], s[44:45], v[8:9]
    v_pk_fma_f32 v[70:71], v[70:71], s[44:45], v[8:9]
    v_pk_mul_f32 v[68:69], v[68:69], v[64:65]
    v_pk_mul_f32 v[70:71], v[70:71], v[66:67]
    v_exp_f32 v68, v68
    v_exp_f32 v69, v69
    v_exp_f32 v70, v70
    v_exp_f32 v71, v71
    s_nop 0
    v_pk_add_f32 v[68:69], v[68:69], s[46:47]
    v_pk_add_f32 v[70:71], v[70:71], s[46:47]
    v_rcp_f32 v68, v68
    v_rcp_f32 v69, v69
    v_rcp_f32 v70, v70
    v_rcp_f32 v71, v71
    s_nop 0
    v_pk_mul_f32 v[68:69], v[68:69], v[64:65]
    v_pk_mul_f32 v[70:71], v[70:71], v[66:67]
    v_cvt_pk_bf16_f32 v72, v68, v69
    v_cvt_pk_bf16_f32 v73, v70, v71
    ds_write_b64 v6, v[72:73] offset:3872
    v_pk_add_f32 v[80:81], v[164:165], v[40:41]
    v_pk_add_f32 v[82:83], v[166:167], v[42:43]
    v_pk_mul_f32 v[84:85], v[80:81], v[80:81]
    v_pk_mul_f32 v[86:87], v[82:83], v[82:83]
    v_pk_fma_f32 v[84:85], v[84:85], s[44:45], v[8:9]
    v_pk_fma_f32 v[86:87], v[86:87], s[44:45], v[8:9]
    v_pk_mul_f32 v[84:85], v[84:85], v[80:81]
    v_pk_mul_f32 v[86:87], v[86:87], v[82:83]
    v_exp_f32 v84, v84
    v_exp_f32 v85, v85
    v_exp_f32 v86, v86
    v_exp_f32 v87, v87
    s_nop 0
    v_pk_add_f32 v[84:85], v[84:85], s[46:47]
    v_pk_add_f32 v[86:87], v[86:87], s[46:47]
    v_rcp_f32 v84, v84
    v_rcp_f32 v85, v85
    v_rcp_f32 v86, v86
    v_rcp_f32 v87, v87
    s_nop 0
    v_pk_mul_f32 v[84:85], v[84:85], v[80:81]
    v_pk_mul_f32 v[86:87], v[86:87], v[82:83]
    v_cvt_pk_bf16_f32 v88, v84, v85
    v_cvt_pk_bf16_f32 v89, v86, v87
    ds_write_b64 v6, v[88:89] offset:3904
    ds_read_b128 v[96:99], v7 offset:0
    ds_read_b128 v[100:103], v7 offset:960
    ds_read_b128 v[104:107], v7 offset:1920
    ds_read_b128 v[108:111], v7 offset:2880
    s_waitcnt lgkmcnt(3)
    s_mov_b32 s28, 0x0
    buffer_store_dwordx4 v[96:99], v5, s[40:43], s28 offen
    s_waitcnt lgkmcnt(2)
    s_mov_b32 s28, 0x9000
    buffer_store_dwordx4 v[100:103], v5, s[40:43], s28 offen
    s_waitcnt lgkmcnt(1)
    s_mov_b32 s28, 0x12000
    buffer_store_dwordx4 v[104:107], v5, s[40:43], s28 offen
    s_waitcnt lgkmcnt(0)
    s_mov_b32 s28, 0x1b000
    buffer_store_dwordx4 v[108:111], v5, s[40:43], s28 offen
    v_pk_add_f32 v[64:65], v[168:169], v[44:45]
    v_pk_add_f32 v[66:67], v[170:171], v[46:47]
    v_pk_mul_f32 v[68:69], v[64:65], v[64:65]
    v_pk_mul_f32 v[70:71], v[66:67], v[66:67]
    v_pk_fma_f32 v[68:69], v[68:69], s[44:45], v[8:9]
    v_pk_fma_f32 v[70:71], v[70:71], s[44:45], v[8:9]
    v_pk_mul_f32 v[68:69], v[68:69], v[64:65]
    v_pk_mul_f32 v[70:71], v[70:71], v[66:67]
    v_exp_f32 v68, v68
    v_exp_f32 v69, v69
    v_exp_f32 v70, v70
    v_exp_f32 v71, v71
    s_nop 0
    v_pk_add_f32 v[68:69], v[68:69], s[46:47]
    v_pk_add_f32 v[70:71], v[70:71], s[46:47]
    v_rcp_f32 v68, v68
    v_rcp_f32 v69, v69
    v_rcp_f32 v70, v70
    v_rcp_f32 v71, v71
    s_nop 0
    v_pk_mul_f32 v[68:69], v[68:69], v[64:65]
    v_pk_mul_f32 v[70:71], v[70:71], v[66:67]
    v_cvt_pk_bf16_f32 v72, v68, v69
    v_cvt_pk_bf16_f32 v73, v70, v71
    ds_write_b64 v6, v[72:73] offset:3936
    v_pk_add_f32 v[80:81], v[172:173], v[48:49]
    v_pk_add_f32 v[82:83], v[174:175], v[50:51]
    v_pk_mul_f32 v[84:85], v[80:81], v[80:81]
    v_pk_mul_f32 v[86:87], v[82:83], v[82:83]
    v_pk_fma_f32 v[84:85], v[84:85], s[44:45], v[8:9]
    v_pk_fma_f32 v[86:87], v[86:87], s[44:45], v[8:9]
    v_pk_mul_f32 v[84:85], v[84:85], v[80:81]
    v_pk_mul_f32 v[86:87], v[86:87], v[82:83]
    v_exp_f32 v84, v84
    v_exp_f32 v85, v85
    v_exp_f32 v86, v86
    v_exp_f32 v87, v87
    s_nop 0
    v_pk_add_f32 v[84:85], v[84:85], s[46:47]
    v_pk_add_f32 v[86:87], v[86:87], s[46:47]
    v_rcp_f32 v84, v84
    v_rcp_f32 v85, v85
    v_rcp_f32 v86, v86
    v_rcp_f32 v87, v87
    s_nop 0
    v_pk_mul_f32 v[84:85], v[84:85], v[80:81]
    v_pk_mul_f32 v[86:87], v[86:87], v[82:83]
    v_cvt_pk_bf16_f32 v88, v84, v85
    v_cvt_pk_bf16_f32 v89, v86, v87
    ds_write_b64 v6, v[88:89] offset:3968
    v_pk_add_f32 v[64:65], v[176:177], v[52:53]
    v_pk_add_f32 v[66:67], v[178:179], v[54:55]
    v_pk_mul_f32 v[68:69], v[64:65], v[64:65]
    v_pk_mul_f32 v[70:71], v[66:67], v[66:67]
    v_pk_fma_f32 v[68:69], v[68:69], s[44:45], v[8:9]
    v_pk_fma_f32 v[70:71], v[70:71], s[44:45], v[8:9]
    v_pk_mul_f32 v[68:69], v[68:69], v[64:65]
    v_pk_mul_f32 v[70:71], v[70:71], v[66:67]
    v_exp_f32 v68, v68
    v_exp_f32 v69, v69
    v_exp_f32 v70, v70
    v_exp_f32 v71, v71
    s_nop 0
    v_pk_add_f32 v[68:69], v[68:69], s[46:47]
    v_pk_add_f32 v[70:71], v[70:71], s[46:47]
    v_rcp_f32 v68, v68
    v_rcp_f32 v69, v69
    v_rcp_f32 v70, v70
    v_rcp_f32 v71, v71
    s_nop 0
    v_pk_mul_f32 v[68:69], v[68:69], v[64:65]
    v_pk_mul_f32 v[70:71], v[70:71], v[66:67]
    v_cvt_pk_bf16_f32 v72, v68, v69
    v_cvt_pk_bf16_f32 v73, v70, v71
    ds_write_b64 v6, v[72:73] offset:4000
    v_pk_add_f32 v[80:81], v[180:181], v[56:57]
    v_pk_add_f32 v[82:83], v[182:183], v[58:59]
    v_pk_mul_f32 v[84:85], v[80:81], v[80:81]
    v_pk_mul_f32 v[86:87], v[82:83], v[82:83]
    v_pk_fma_f32 v[84:85], v[84:85], s[44:45], v[8:9]
    v_pk_fma_f32 v[86:87], v[86:87], s[44:45], v[8:9]
    v_pk_mul_f32 v[84:85], v[84:85], v[80:81]
    v_pk_mul_f32 v[86:87], v[86:87], v[82:83]
    v_exp_f32 v84, v84
    v_exp_f32 v85, v85
    v_exp_f32 v86, v86
    v_exp_f32 v87, v87
    s_nop 0
    v_pk_add_f32 v[84:85], v[84:85], s[46:47]
    v_pk_add_f32 v[86:87], v[86:87], s[46:47]
    v_rcp_f32 v84, v84
    v_rcp_f32 v85, v85
    v_rcp_f32 v86, v86
    v_rcp_f32 v87, v87
    s_nop 0
    v_pk_mul_f32 v[84:85], v[84:85], v[80:81]
    v_pk_mul_f32 v[86:87], v[86:87], v[82:83]
    v_cvt_pk_bf16_f32 v88, v84, v85
    v_cvt_pk_bf16_f32 v89, v86, v87
    ds_write_b64 v6, v[88:89] offset:4032
    s_waitcnt lgkmcnt(0)
    v_pk_add_f32 v[64:65], v[184:185], v[32:33]
    v_pk_add_f32 v[66:67], v[186:187], v[34:35]
    v_pk_mul_f32 v[68:69], v[64:65], v[64:65]
    v_pk_mul_f32 v[70:71], v[66:67], v[66:67]
    v_pk_fma_f32 v[68:69], v[68:69], s[44:45], v[8:9]
    v_pk_fma_f32 v[70:71], v[70:71], s[44:45], v[8:9]
    v_pk_mul_f32 v[68:69], v[68:69], v[64:65]
    v_pk_mul_f32 v[70:71], v[70:71], v[66:67]
    v_exp_f32 v68, v68
    v_exp_f32 v69, v69
    v_exp_f32 v70, v70
    v_exp_f32 v71, v71
    s_nop 0
    v_pk_add_f32 v[68:69], v[68:69], s[46:47]
    v_pk_add_f32 v[70:71], v[70:71], s[46:47]
    v_rcp_f32 v68, v68
    v_rcp_f32 v69, v69
    v_rcp_f32 v70, v70
    v_rcp_f32 v71, v71
    s_nop 0
    v_pk_mul_f32 v[68:69], v[68:69], v[64:65]
    v_pk_mul_f32 v[70:71], v[70:71], v[66:67]
    v_cvt_pk_bf16_f32 v72, v68, v69
    v_cvt_pk_bf16_f32 v73, v70, v71
    ds_write_b64 v6, v[72:73] offset:7680
    v_pk_add_f32 v[80:81], v[188:189], v[36:37]
    v_pk_add_f32 v[82:83], v[190:191], v[38:39]
    v_pk_mul_f32 v[84:85], v[80:81], v[80:81]
    v_pk_mul_f32 v[86:87], v[82:83], v[82:83]
    v_pk_fma_f32 v[84:85], v[84:85], s[44:45], v[8:9]
    v_pk_fma_f32 v[86:87], v[86:87], s[44:45], v[8:9]
    v_pk_mul_f32 v[84:85], v[84:85], v[80:81]
    v_pk_mul_f32 v[86:87], v[86:87], v[82:83]
    v_exp_f32 v84, v84
    v_exp_f32 v85, v85
    v_exp_f32 v86, v86
    v_exp_f32 v87, v87
    s_nop 0
    v_pk_add_f32 v[84:85], v[84:85], s[46:47]
    v_pk_add_f32 v[86:87], v[86:87], s[46:47]
    v_rcp_f32 v84, v84
    v_rcp_f32 v85, v85
    v_rcp_f32 v86, v86
    v_rcp_f32 v87, v87
    s_nop 0
    v_pk_mul_f32 v[84:85], v[84:85], v[80:81]
    v_pk_mul_f32 v[86:87], v[86:87], v[82:83]
    v_cvt_pk_bf16_f32 v88, v84, v85
    v_cvt_pk_bf16_f32 v89, v86, v87
    ds_write_b64 v6, v[88:89] offset:7712
    v_pk_add_f32 v[64:65], v[192:193], v[40:41]
    v_pk_add_f32 v[66:67], v[194:195], v[42:43]
    v_pk_mul_f32 v[68:69], v[64:65], v[64:65]
    v_pk_mul_f32 v[70:71], v[66:67], v[66:67]
    v_pk_fma_f32 v[68:69], v[68:69], s[44:45], v[8:9]
    v_pk_fma_f32 v[70:71], v[70:71], s[44:45], v[8:9]
    v_pk_mul_f32 v[68:69], v[68:69], v[64:65]
    v_pk_mul_f32 v[70:71], v[70:71], v[66:67]
    v_exp_f32 v68, v68
    v_exp_f32 v69, v69
    v_exp_f32 v70, v70
    v_exp_f32 v71, v71
    s_nop 0
    v_pk_add_f32 v[68:69], v[68:69], s[46:47]
    v_pk_add_f32 v[70:71], v[70:71], s[46:47]
    v_rcp_f32 v68, v68
    v_rcp_f32 v69, v69
    v_rcp_f32 v70, v70
    v_rcp_f32 v71, v71
    s_nop 0
    v_pk_mul_f32 v[68:69], v[68:69], v[64:65]
    v_pk_mul_f32 v[70:71], v[70:71], v[66:67]
    v_cvt_pk_bf16_f32 v72, v68, v69
    v_cvt_pk_bf16_f32 v73, v70, v71
    ds_write_b64 v6, v[72:73] offset:7744
    ds_read_b128 v[96:99], v7 offset:3840
    ds_read_b128 v[100:103], v7 offset:4800
    ds_read_b128 v[104:107], v7 offset:5760
    ds_read_b128 v[108:111], v7 offset:6720
    s_waitcnt lgkmcnt(3)
    s_mov_b32 s28, 0x24000
    buffer_store_dwordx4 v[96:99], v5, s[40:43], s28 offen
    s_waitcnt lgkmcnt(2)
    s_mov_b32 s28, 0x2d000
    buffer_store_dwordx4 v[100:103], v5, s[40:43], s28 offen
    s_waitcnt lgkmcnt(1)
    s_mov_b32 s28, 0x36000
    buffer_store_dwordx4 v[104:107], v5, s[40:43], s28 offen
    s_waitcnt lgkmcnt(0)
    s_mov_b32 s28, 0x3f000
    buffer_store_dwordx4 v[108:111], v5, s[40:43], s28 offen
    v_pk_add_f32 v[80:81], v[196:197], v[44:45]
    v_pk_add_f32 v[82:83], v[198:199], v[46:47]
    v_pk_mul_f32 v[84:85], v[80:81], v[80:81]
    v_pk_mul_f32 v[86:87], v[82:83], v[82:83]
    v_pk_fma_f32 v[84:85], v[84:85], s[44:45], v[8:9]
    v_pk_fma_f32 v[86:87], v[86:87], s[44:45], v[8:9]
    v_pk_mul_f32 v[84:85], v[84:85], v[80:81]
    v_pk_mul_f32 v[86:87], v[86:87], v[82:83]
    v_exp_f32 v84, v84
    v_exp_f32 v85, v85
    v_exp_f32 v86, v86
    v_exp_f32 v87, v87
    s_nop 0
    v_pk_add_f32 v[84:85], v[84:85], s[46:47]
    v_pk_add_f32 v[86:87], v[86:87], s[46:47]
    v_rcp_f32 v84, v84
    v_rcp_f32 v85, v85
    v_rcp_f32 v86, v86
    v_rcp_f32 v87, v87
    s_nop 0
    v_pk_mul_f32 v[84:85], v[84:85], v[80:81]
    v_pk_mul_f32 v[86:87], v[86:87], v[82:83]
    v_cvt_pk_bf16_f32 v88, v84, v85
    v_cvt_pk_bf16_f32 v89, v86, v87
    ds_write_b64 v6, v[88:89] offset:7776
    v_pk_add_f32 v[64:65], v[200:201], v[48:49]
    v_pk_add_f32 v[66:67], v[202:203], v[50:51]
    v_pk_mul_f32 v[68:69], v[64:65], v[64:65]
    v_pk_mul_f32 v[70:71], v[66:67], v[66:67]
    v_pk_fma_f32 v[68:69], v[68:69], s[44:45], v[8:9]
    v_pk_fma_f32 v[70:71], v[70:71], s[44:45], v[8:9]
    v_pk_mul_f32 v[68:69], v[68:69], v[64:65]
    v_pk_mul_f32 v[70:71], v[70:71], v[66:67]
    v_exp_f32 v68, v68
    v_exp_f32 v69, v69
    v_exp_f32 v70, v70
    v_exp_f32 v71, v71
    s_nop 0
    v_pk_add_f32 v[68:69], v[68:69], s[46:47]
    v_pk_add_f32 v[70:71], v[70:71], s[46:47]
    v_rcp_f32 v68, v68
    v_rcp_f32 v69, v69
    v_rcp_f32 v70, v70
    v_rcp_f32 v71, v71
    s_nop 0
    v_pk_mul_f32 v[68:69], v[68:69], v[64:65]
    v_pk_mul_f32 v[70:71], v[70:71], v[66:67]
    v_cvt_pk_bf16_f32 v72, v68, v69
    v_cvt_pk_bf16_f32 v73, v70, v71
    ds_write_b64 v6, v[72:73] offset:7808
    v_pk_add_f32 v[80:81], v[204:205], v[52:53]
    v_pk_add_f32 v[82:83], v[206:207], v[54:55]
    v_pk_mul_f32 v[84:85], v[80:81], v[80:81]
    v_pk_mul_f32 v[86:87], v[82:83], v[82:83]
    v_pk_fma_f32 v[84:85], v[84:85], s[44:45], v[8:9]
    v_pk_fma_f32 v[86:87], v[86:87], s[44:45], v[8:9]
    v_pk_mul_f32 v[84:85], v[84:85], v[80:81]
    v_pk_mul_f32 v[86:87], v[86:87], v[82:83]
    v_exp_f32 v84, v84
    v_exp_f32 v85, v85
    v_exp_f32 v86, v86
    v_exp_f32 v87, v87
    s_nop 0
    v_pk_add_f32 v[84:85], v[84:85], s[46:47]
    v_pk_add_f32 v[86:87], v[86:87], s[46:47]
    v_rcp_f32 v84, v84
    v_rcp_f32 v85, v85
    v_rcp_f32 v86, v86
    v_rcp_f32 v87, v87
    s_nop 0
    v_pk_mul_f32 v[84:85], v[84:85], v[80:81]
    v_pk_mul_f32 v[86:87], v[86:87], v[82:83]
    v_cvt_pk_bf16_f32 v88, v84, v85
    v_cvt_pk_bf16_f32 v89, v86, v87
    ds_write_b64 v6, v[88:89] offset:7840
    v_pk_add_f32 v[64:65], v[208:209], v[56:57]
    v_pk_add_f32 v[66:67], v[210:211], v[58:59]
    v_pk_mul_f32 v[68:69], v[64:65], v[64:65]
    v_pk_mul_f32 v[70:71], v[66:67], v[66:67]
    v_pk_fma_f32 v[68:69], v[68:69], s[44:45], v[8:9]
    v_pk_fma_f32 v[70:71], v[70:71], s[44:45], v[8:9]
    v_pk_mul_f32 v[68:69], v[68:69], v[64:65]
    v_pk_mul_f32 v[70:71], v[70:71], v[66:67]
    v_exp_f32 v68, v68
    v_exp_f32 v69, v69
    v_exp_f32 v70, v70
    v_exp_f32 v71, v71
    s_nop 0
    v_pk_add_f32 v[68:69], v[68:69], s[46:47]
    v_pk_add_f32 v[70:71], v[70:71], s[46:47]
    v_rcp_f32 v68, v68
    v_rcp_f32 v69, v69
    v_rcp_f32 v70, v70
    v_rcp_f32 v71, v71
    s_nop 0
    v_pk_mul_f32 v[68:69], v[68:69], v[64:65]
    v_pk_mul_f32 v[70:71], v[70:71], v[66:67]
    v_cvt_pk_bf16_f32 v72, v68, v69
    v_cvt_pk_bf16_f32 v73, v70, v71
    ds_write_b64 v6, v[72:73] offset:7872
    s_waitcnt lgkmcnt(0)
    v_pk_add_f32 v[80:81], v[212:213], v[32:33]
    v_pk_add_f32 v[82:83], v[214:215], v[34:35]
    v_pk_mul_f32 v[84:85], v[80:81], v[80:81]
    v_pk_mul_f32 v[86:87], v[82:83], v[82:83]
    v_pk_fma_f32 v[84:85], v[84:85], s[44:45], v[8:9]
    v_pk_fma_f32 v[86:87], v[86:87], s[44:45], v[8:9]
    v_pk_mul_f32 v[84:85], v[84:85], v[80:81]
    v_pk_mul_f32 v[86:87], v[86:87], v[82:83]
    v_exp_f32 v84, v84
    v_exp_f32 v85, v85
    v_exp_f32 v86, v86
    v_exp_f32 v87, v87
    s_nop 0
    v_pk_add_f32 v[84:85], v[84:85], s[46:47]
    v_pk_add_f32 v[86:87], v[86:87], s[46:47]
    v_rcp_f32 v84, v84
    v_rcp_f32 v85, v85
    v_rcp_f32 v86, v86
    v_rcp_f32 v87, v87
    s_nop 0
    v_pk_mul_f32 v[84:85], v[84:85], v[80:81]
    v_pk_mul_f32 v[86:87], v[86:87], v[82:83]
    v_cvt_pk_bf16_f32 v88, v84, v85
    v_cvt_pk_bf16_f32 v89, v86, v87
    ds_write_b64 v6, v[88:89] offset:11520
    v_pk_add_f32 v[64:65], v[216:217], v[36:37]
    v_pk_add_f32 v[66:67], v[218:219], v[38:39]
    v_pk_mul_f32 v[68:69], v[64:65], v[64:65]
    v_pk_mul_f32 v[70:71], v[66:67], v[66:67]
    v_pk_fma_f32 v[68:69], v[68:69], s[44:45], v[8:9]
    v_pk_fma_f32 v[70:71], v[70:71], s[44:45], v[8:9]
    v_pk_mul_f32 v[68:69], v[68:69], v[64:65]
    v_pk_mul_f32 v[70:71], v[70:71], v[66:67]
    v_exp_f32 v68, v68
    v_exp_f32 v69, v69
    v_exp_f32 v70, v70
    v_exp_f32 v71, v71
    s_nop 0
    v_pk_add_f32 v[68:69], v[68:69], s[46:47]
    v_pk_add_f32 v[70:71], v[70:71], s[46:47]
    v_rcp_f32 v68, v68
    v_rcp_f32 v69, v69
    v_rcp_f32 v70, v70
    v_rcp_f32 v71, v71
    s_nop 0
    v_pk_mul_f32 v[68:69], v[68:69], v[64:65]
    v_pk_mul_f32 v[70:71], v[70:71], v[66:67]
    v_cvt_pk_bf16_f32 v72, v68, v69
    v_cvt_pk_bf16_f32 v73, v70, v71
    ds_write_b64 v6, v[72:73] offset:11552
    v_pk_add_f32 v[80:81], v[220:221], v[40:41]
    v_pk_add_f32 v[82:83], v[222:223], v[42:43]
    v_pk_mul_f32 v[84:85], v[80:81], v[80:81]
    v_pk_mul_f32 v[86:87], v[82:83], v[82:83]
    v_pk_fma_f32 v[84:85], v[84:85], s[44:45], v[8:9]
    v_pk_fma_f32 v[86:87], v[86:87], s[44:45], v[8:9]
    v_pk_mul_f32 v[84:85], v[84:85], v[80:81]
    v_pk_mul_f32 v[86:87], v[86:87], v[82:83]
    v_exp_f32 v84, v84
    v_exp_f32 v85, v85
    v_exp_f32 v86, v86
    v_exp_f32 v87, v87
    s_nop 0
    v_pk_add_f32 v[84:85], v[84:85], s[46:47]
    v_pk_add_f32 v[86:87], v[86:87], s[46:47]
    v_rcp_f32 v84, v84
    v_rcp_f32 v85, v85
    v_rcp_f32 v86, v86
    v_rcp_f32 v87, v87
    s_nop 0
    v_pk_mul_f32 v[84:85], v[84:85], v[80:81]
    v_pk_mul_f32 v[86:87], v[86:87], v[82:83]
    v_cvt_pk_bf16_f32 v88, v84, v85
    v_cvt_pk_bf16_f32 v89, v86, v87
    ds_write_b64 v6, v[88:89] offset:11584
    ds_read_b128 v[96:99], v7 offset:7680
    ds_read_b128 v[100:103], v7 offset:8640
    ds_read_b128 v[104:107], v7 offset:9600
    ds_read_b128 v[108:111], v7 offset:10560
    s_waitcnt lgkmcnt(3)
    s_mov_b32 s28, 0x48000
    buffer_store_dwordx4 v[96:99], v5, s[40:43], s28 offen
    s_waitcnt lgkmcnt(2)
    s_mov_b32 s28, 0x51000
    buffer_store_dwordx4 v[100:103], v5, s[40:43], s28 offen
    s_waitcnt lgkmcnt(1)
    s_mov_b32 s28, 0x5a000
    buffer_store_dwordx4 v[104:107], v5, s[40:43], s28 offen
    s_waitcnt lgkmcnt(0)
    s_mov_b32 s28, 0x63000
    buffer_store_dwordx4 v[108:111], v5, s[40:43], s28 offen
    v_pk_add_f32 v[64:65], v[224:225], v[44:45]
    v_pk_add_f32 v[66:67], v[226:227], v[46:47]
    v_pk_mul_f32 v[68:69], v[64:65], v[64:65]
    v_pk_mul_f32 v[70:71], v[66:67], v[66:67]
    v_pk_fma_f32 v[68:69], v[68:69], s[44:45], v[8:9]
    v_pk_fma_f32 v[70:71], v[70:71], s[44:45], v[8:9]
    v_pk_mul_f32 v[68:69], v[68:69], v[64:65]
    v_pk_mul_f32 v[70:71], v[70:71], v[66:67]
    v_exp_f32 v68, v68
    v_exp_f32 v69, v69
    v_exp_f32 v70, v70
    v_exp_f32 v71, v71
    s_nop 0
    v_pk_add_f32 v[68:69], v[68:69], s[46:47]
    v_pk_add_f32 v[70:71], v[70:71], s[46:47]
    v_rcp_f32 v68, v68
    v_rcp_f32 v69, v69
    v_rcp_f32 v70, v70
    v_rcp_f32 v71, v71
    s_nop 0
    v_pk_mul_f32 v[68:69], v[68:69], v[64:65]
    v_pk_mul_f32 v[70:71], v[70:71], v[66:67]
    v_cvt_pk_bf16_f32 v72, v68, v69
    v_cvt_pk_bf16_f32 v73, v70, v71
    ds_write_b64 v6, v[72:73] offset:11616
    v_pk_add_f32 v[80:81], v[228:229], v[48:49]
    v_pk_add_f32 v[82:83], v[230:231], v[50:51]
    v_pk_mul_f32 v[84:85], v[80:81], v[80:81]
    v_pk_mul_f32 v[86:87], v[82:83], v[82:83]
    v_pk_fma_f32 v[84:85], v[84:85], s[44:45], v[8:9]
    v_pk_fma_f32 v[86:87], v[86:87], s[44:45], v[8:9]
    v_pk_mul_f32 v[84:85], v[84:85], v[80:81]
    v_pk_mul_f32 v[86:87], v[86:87], v[82:83]
    v_exp_f32 v84, v84
    v_exp_f32 v85, v85
    v_exp_f32 v86, v86
    v_exp_f32 v87, v87
    s_nop 0
    v_pk_add_f32 v[84:85], v[84:85], s[46:47]
    v_pk_add_f32 v[86:87], v[86:87], s[46:47]
    v_rcp_f32 v84, v84
    v_rcp_f32 v85, v85
    v_rcp_f32 v86, v86
    v_rcp_f32 v87, v87
    s_nop 0
    v_pk_mul_f32 v[84:85], v[84:85], v[80:81]
    v_pk_mul_f32 v[86:87], v[86:87], v[82:83]
    v_cvt_pk_bf16_f32 v88, v84, v85
    v_cvt_pk_bf16_f32 v89, v86, v87
    ds_write_b64 v6, v[88:89] offset:11648
    v_pk_add_f32 v[64:65], v[232:233], v[52:53]
    v_pk_add_f32 v[66:67], v[234:235], v[54:55]
    v_pk_mul_f32 v[68:69], v[64:65], v[64:65]
    v_pk_mul_f32 v[70:71], v[66:67], v[66:67]
    v_pk_fma_f32 v[68:69], v[68:69], s[44:45], v[8:9]
    v_pk_fma_f32 v[70:71], v[70:71], s[44:45], v[8:9]
    v_pk_mul_f32 v[68:69], v[68:69], v[64:65]
    v_pk_mul_f32 v[70:71], v[70:71], v[66:67]
    v_exp_f32 v68, v68
    v_exp_f32 v69, v69
    v_exp_f32 v70, v70
    v_exp_f32 v71, v71
    s_nop 0
    v_pk_add_f32 v[68:69], v[68:69], s[46:47]
    v_pk_add_f32 v[70:71], v[70:71], s[46:47]
    v_rcp_f32 v68, v68
    v_rcp_f32 v69, v69
    v_rcp_f32 v70, v70
    v_rcp_f32 v71, v71
    s_nop 0
    v_pk_mul_f32 v[68:69], v[68:69], v[64:65]
    v_pk_mul_f32 v[70:71], v[70:71], v[66:67]
    v_cvt_pk_bf16_f32 v72, v68, v69
    v_cvt_pk_bf16_f32 v73, v70, v71
    ds_write_b64 v6, v[72:73] offset:11680
    v_pk_add_f32 v[80:81], v[236:237], v[56:57]
    v_pk_add_f32 v[82:83], v[238:239], v[58:59]
    v_pk_mul_f32 v[84:85], v[80:81], v[80:81]
    v_pk_mul_f32 v[86:87], v[82:83], v[82:83]
    v_pk_fma_f32 v[84:85], v[84:85], s[44:45], v[8:9]
    v_pk_fma_f32 v[86:87], v[86:87], s[44:45], v[8:9]
    v_pk_mul_f32 v[84:85], v[84:85], v[80:81]
    v_pk_mul_f32 v[86:87], v[86:87], v[82:83]
    v_exp_f32 v84, v84
    v_exp_f32 v85, v85
    v_exp_f32 v86, v86
    v_exp_f32 v87, v87
    s_nop 0
    v_pk_add_f32 v[84:85], v[84:85], s[46:47]
    v_pk_add_f32 v[86:87], v[86:87], s[46:47]
    v_rcp_f32 v84, v84
    v_rcp_f32 v85, v85
    v_rcp_f32 v86, v86
    v_rcp_f32 v87, v87
    s_nop 0
    v_pk_mul_f32 v[84:85], v[84:85], v[80:81]
    v_pk_mul_f32 v[86:87], v[86:87], v[82:83]
    v_cvt_pk_bf16_f32 v88, v84, v85
    v_cvt_pk_bf16_f32 v89, v86, v87
    ds_write_b64 v6, v[88:89] offset:11712
    s_waitcnt lgkmcnt(0)
    ds_read_b128 v[96:99], v7 offset:11520
    ds_read_b128 v[100:103], v7 offset:12480
    ds_read_b128 v[104:107], v7 offset:13440
    ds_read_b128 v[108:111], v7 offset:14400
    s_waitcnt lgkmcnt(3)
    s_mov_b32 s28, 0x6c000
    buffer_store_dwordx4 v[96:99], v5, s[40:43], s28 offen
    s_waitcnt lgkmcnt(2)
    s_mov_b32 s28, 0x75000
    buffer_store_dwordx4 v[100:103], v5, s[40:43], s28 offen
    s_waitcnt lgkmcnt(1)
    s_mov_b32 s28, 0x7e000
    buffer_store_dwordx4 v[104:107], v5, s[40:43], s28 offen
    s_waitcnt lgkmcnt(0)
    s_mov_b32 s28, 0x87000
    buffer_store_dwordx4 v[108:111], v5, s[40:43], s28 offen
g1_fin:
g1_done:
    s_endpgm
.globl gemm2_kernel
.p2align 8
.type gemm2_kernel,@function
gemm2_kernel:
    s_cmp_ge_u32 s2, 256
    s_cbranch_scc1 g2_done
    s_load_dwordx2 s[4:5], s[0:1], 88
    s_load_dwordx2 s[6:7], s[0:1], 56
    s_load_dwordx2 s[30:31], s[0:1], 24
    s_load_dwordx2 s[32:33], s[0:1], 0
    s_load_dwordx2 s[34:35], s[0:1], 64
    s_load_dwordx2 s[36:37], s[0:1], 72
    v_and_b32 v1, 63, v0
    v_lshrrev_b32 v2, 6, v0
    s_nop 0
    v_readfirstlane_b32 s20, v2
    v_and_b32 v3, 15, v1
    v_lshrrev_b32 v4, 4, v1
    s_and_b32 s21, s2, 7
    s_lshr_b32 s23, s2, 7
    s_bfe_u32 s24, s2, 0x20003
    s_and_b32 s25, s21, 3
    s_lshl_b32 s25, s25, 2
    s_add_u32 s24, s24, s25
    s_bfe_u32 s25, s2, 0x20005
    s_lshr_b32 s26, s21, 2
    s_lshl_b32 s26, s26, 2
    s_add_u32 s25, s25, s26
    s_lshr_b32 s21, s20, 2
    s_bfe_u32 s22, s20, 0x10001
    s_and_b32 s26, s20, 1
    s_lshl_b32 s27, s20, 11
    s_waitcnt lgkmcnt(0)
    s_add_u32 s8, s4, 0x400000
    s_addc_u32 s9, s5, 0
    s_and_b32 s9, s9, 0xffff
    s_mov_b32 s10, 0x1200000
    s_mov_b32 s11, 0x00020000
    s_add_u32 s44, s4, 0x3800000
    s_addc_u32 s45, s5, 0
    s_and_b32 s45, s45, 0xffff
    s_mov_b32 s46, 0x10000
    s_mov_b32 s47, 0x00020000
    s_cmp_lg_u32 s23, 0
    s_cbranch_scc1 g2_noapply
    s_and_b32 s57, s2, 15
    s_lshr_b32 s58, s2, 4
    s_lshr_b32 s59, s20, 1
    s_and_b32 s38, s20, 1
    s_add_u32 s48, s4, 0x1800000
    s_addc_u32 s49, s5, 0
    s_and_b32 s49, s49, 0xffff
    s_mov_b32 s50, 0x800000
    s_mov_b32 s51, 0x00020000
    s_add_u32 s52, s4, 0x2000000
    s_addc_u32 s53, s5, 0
    s_and_b32 s53, s53, 0xffff
    s_mov_b32 s54, 0x400000
    s_mov_b32 s55, 0x00020000
    s_mul_i32 s56, s20, 12288
    v_lshlrev_b32 v7, 4, v1
    s_lshl_b32 s28, s57, 3
    s_add_u32 s28, s28, s58
    s_lshl_b32 s28, s28, 3
    s_add_u32 s28, s28, s20
    s_lshl_b32 s28, s28, 13
    v_add_u32 v10, s28, v7
    s_movk_i32 s29, 4096
    buffer_load_dwordx4 v[128:131], v10, s[48:51], 0 offen offset:0
    buffer_load_dwordx4 v[132:135], v10, s[48:51], 0 offen offset:1024
    buffer_load_dwordx4 v[136:139], v10, s[48:51], 0 offen offset:2048
    buffer_load_dwordx4 v[140:143], v10, s[48:51], 0 offen offset:3072
    buffer_load_dwordx4 v[144:147], v10, s[48:51], s29 offen offset:0
    buffer_load_dwordx4 v[148:151], v10, s[48:51], s29 offen offset:1024
    buffer_load_dwordx4 v[152:155], v10, s[48:51], s29 offen offset:2048
    buffer_load_dwordx4 v[156:159], v10, s[48:51], s29 offen offset:3072
    s_mul_i32 s28, s57, 192
    s_mul_i32 s29, s20, 3
    s_add_u32 s28, s28, s29
    s_lshl_b32 s28, s28, 10
    v_add_u32 v10, s28, v7
    s_mov_b32 s28, 0x0
    buffer_load_dwordx4 v[32:35], v10, s[52:55], s28 offen offset:0
    buffer_load_dwordx4 v[36:39], v10, s[52:55], s28 offen offset:1024
    buffer_load_dwordx4 v[40:43], v10, s[52:55], s28 offen offset:2048
    s_mov_b32 s28, 0x6000
    buffer_load_dwordx4 v[44:47], v10, s[52:55], s28 offen offset:0
    buffer_load_dwordx4 v[48:51], v10, s[52:55], s28 offen offset:1024
    buffer_load_dwordx4 v[52:55], v10, s[52:55], s28 offen offset:2048
    s_mov_b32 s28, 0xc000
    buffer_load_dwordx4 v[56:59], v10, s[52:55], s28 offen offset:0
    buffer_load_dwordx4 v[60:63], v10, s[52:55], s28 offen offset:1024
    buffer_load_dwordx4 v[64:67], v10, s[52:55], s28 offen offset:2048
    s_mov_b32 s28, 0x12000
    buffer_load_dwordx4 v[68:71], v10, s[52:55], s28 offen offset:0
    buffer_load_dwordx4 v[72:75], v10, s[52:55], s28 offen offset:1024
    buffer_load_dwordx4 v[76:79], v10, s[52:55], s28 offen offset:2048
    s_mov_b32 s28, 0x18000
    buffer_load_dwordx4 v[80:83], v10, s[52:55], s28 offen offset:0
    buffer_load_dwordx4 v[84:87], v10, s[52:55], s28 offen offset:1024
    buffer_load_dwordx4 v[88:91], v10, s[52:55], s28 offen offset:2048
    s_mov_b32 s28, 0x1e000
    buffer_load_dwordx4 v[92:95], v10, s[52:55], s28 offen offset:0
    buffer_load_dwordx4 v[96:99], v10, s[52:55], s28 offen offset:1024
    buffer_load_dwordx4 v[100:103], v10, s[52:55], s28 offen offset:2048
    s_mov_b32 s28, 0x24000
    buffer_load_dwordx4 v[104:107], v10, s[52:55], s28 offen offset:0
    buffer_load_dwordx4 v[108:111], v10, s[52:55], s28 offen offset:1024
    buffer_load_dwordx4 v[112:115], v10, s[52:55], s28 offen offset:2048
    s_mov_b32 s28, 0x2a000
    buffer_load_dwordx4 v[116:119], v10, s[52:55], s28 offen offset:0
    buffer_load_dwordx4 v[120:123], v10, s[52:55], s28 offen offset:1024
    buffer_load_dwordx4 v[124:127], v10, s[52:55], s28 offen offset:2048
    s_mul_i32 s28, s20, 1536
    s_add_u32 s28, s28, 98304
    v_lshl_add_u32 v8, v1, 3, s28
    s_mul_i32 s28, s38, 6144
    s_add_u32 s28, s28, 98304
    v_lshl_add_u32 v9, v1, 3, s28
    s_waitcnt vmcnt(18)
    v_pk_add_f32 v[32:33], v[32:33], v[44:45]
    v_pk_add_f32 v[34:35], v[34:35], v[46:47]
    v_pk_add_f32 v[36:37], v[36:37], v[48:49]
    v_pk_add_f32 v[38:39], v[38:39], v[50:51]
    v_pk_add_f32 v[40:41], v[40:41], v[52:53]
    v_pk_add_f32 v[42:43], v[42:43], v[54:55]
    s_waitcnt vmcnt(15)
    v_pk_add_f32 v[32:33], v[32:33], v[56:57]
    v_pk_add_f32 v[34:35], v[34:35], v[58:59]
    v_pk_add_f32 v[36:37], v[36:37], v[60:61]
    v_pk_add_f32 v[38:39], v[38:39], v[62:63]
    v_pk_add_f32 v[40:41], v[40:41], v[64:65]
    v_pk_add_f32 v[42:43], v[42:43], v[66:67]
    s_waitcnt vmcnt(12)
    v_pk_add_f32 v[32:33], v[32:33], v[68:69]
    v_pk_add_f32 v[34:35], v[34:35], v[70:71]
    v_pk_add_f32 v[36:37], v[36:37], v[72:73]
    v_pk_add_f32 v[38:39], v[38:39], v[74:75]
    v_pk_add_f32 v[40:41], v[40:41], v[76:77]
    v_pk_add_f32 v[42:43], v[42:43], v[78:79]
    s_waitcnt vmcnt(9)
    v_pk_add_f32 v[32:33], v[32:33], v[80:81]
    v_pk_add_f32 v[34:35], v[34:35], v[82:83]
    v_pk_add_f32 v[36:37], v[36:37], v[84:85]
    v_pk_add_f32 v[38:39], v[38:39], v[86:87]
    v_pk_add_f32 v[40:41], v[40:41], v[88:89]
    v_pk_add_f32 v[42:43], v[42:43], v[90:91]
    s_waitcnt vmcnt(6)
    v_pk_add_f32 v[32:33], v[32:33], v[92:93]
    v_pk_add_f32 v[34:35], v[34:35], v[94:95]
    v_pk_add_f32 v[36:37], v[36:37], v[96:97]
    v_pk_add_f32 v[38:39], v[38:39], v[98:99]
    v_pk_add_f32 v[40:41], v[40:41], v[100:101]
    v_pk_add_f32 v[42:43], v[42:43], v[102:103]
    s_waitcnt vmcnt(3)
    v_pk_add_f32 v[32:33], v[32:33], v[104:105]
    v_pk_add_f32 v[34:35], v[34:35], v[106:107]
    v_pk_add_f32 v[36:37], v[36:37], v[108:109]
    v_pk_add_f32 v[38:39], v[38:39], v[110:111]
    v_pk_add_f32 v[40:41], v[40:41], v[112:113]
    v_pk_add_f32 v[42:43], v[42:43], v[114:115]
    s_waitcnt vmcnt(0)
    v_pk_add_f32 v[32:33], v[32:33], v[116:117]
    v_pk_add_f32 v[34:35], v[34:35], v[118:119]
    v_pk_add_f32 v[36:37], v[36:37], v[120:121]
    v_pk_add_f32 v[38:39], v[38:39], v[122:123]
    v_pk_add_f32 v[40:41], v[40:41], v[124:125]
    v_pk_add_f32 v[42:43], v[42:43], v[126:127]
    v_cvt_pk_bf16_f32 v16, v32, v33
    v_cvt_pk_bf16_f32 v17, v34, v35
    v_cvt_pk_bf16_f32 v18, v36, v37
    v_cvt_pk_bf16_f32 v19, v38, v39
    v_cvt_pk_bf16_f32 v20, v40, v41
    v_cvt_pk_bf16_f32 v21, v42, v43
    ds_write_b64 v8, v[16:17] offset:0
    ds_write_b64 v8, v[18:19] offset:512
    ds_write_b64 v8, v[20:21] offset:1024
    s_waitcnt lgkmcnt(0)
    s_barrier
    ds_read_b64 v[32:33], v9 offset:0
    ds_read_b64 v[34:35], v9 offset:1024
    ds_read_b64 v[36:37], v9 offset:2048
    ds_read_b64 v[38:39], v9 offset:3072
    ds_read_b64 v[40:41], v9 offset:512
    ds_read_b64 v[42:43], v9 offset:1536
    ds_read_b64 v[44:45], v9 offset:2560
    ds_read_b64 v[46:47], v9 offset:3584
    ds_read_b64 v[48:49], v9 offset:4096
    ds_read_b64 v[50:51], v9 offset:4608
    ds_read_b64 v[52:53], v9 offset:5120
    ds_read_b64 v[54:55], v9 offset:5632
    s_movk_i32 s28, 80
    v_mul_lo_u32 v5, v3, s28
    v_lshl_add_u32 v5, v4, 3, v5
    v_add_u32 v5, s56, v5
    v_lshrrev_b32 v12, 2, v1
    v_mul_lo_u32 v6, v12, s28
    v_and_b32 v13, 3, v1
    v_lshl_add_u32 v6, v13, 4, v6
    v_add_u32 v6, s56, v6
    s_lshl_b32 s28, s58, 8
    s_lshl_b32 s29, s59, 6
    s_add_u32 s28, s28, s29
    v_add_u32 v12, s28, v12
    s_movk_i32 s28, 9216
    v_mul_lo_u32 v12, v12, s28
    s_lshl_b32 s28, s57, 1
    s_add_u32 s28, s28, s38
    s_lshl_b32 s28, s28, 6
    s_add_u32 s28, s28, 7168
    v_lshl_add_u32 v13, v13, 4, s28
    v_add_u32 v12, v12, v13
    s_waitcnt lgkmcnt(0)
    v_mfma_f32_16x16x32_bf16 v[64:67], v[32:35], v[128:131], 0
    v_mfma_f32_16x16x32_bf16 v[68:71], v[40:43], v[128:131], 0
    v_mfma_f32_16x16x32_bf16 v[72:75], v[48:51], v[128:131], 0
    v_mfma_f32_16x16x32_bf16 v[76:79], v[32:35], v[136:139], 0
    v_mfma_f32_16x16x32_bf16 v[80:83], v[40:43], v[136:139], 0
    v_mfma_f32_16x16x32_bf16 v[84:87], v[48:51], v[136:139], 0
    v_mfma_f32_16x16x32_bf16 v[88:91], v[32:35], v[144:147], 0
    v_mfma_f32_16x16x32_bf16 v[92:95], v[40:43], v[144:147], 0
    v_mfma_f32_16x16x32_bf16 v[96:99], v[48:51], v[144:147], 0
    v_mfma_f32_16x16x32_bf16 v[100:103], v[32:35], v[152:155], 0
    v_mfma_f32_16x16x32_bf16 v[104:107], v[40:43], v[152:155], 0
    v_mfma_f32_16x16x32_bf16 v[108:111], v[48:51], v[152:155], 0
    v_mfma_f32_16x16x32_bf16 v[64:67], v[36:39], v[132:135], v[64:67]
    v_mfma_f32_16x16x32_bf16 v[68:71], v[44:47], v[132:135], v[68:71]
    v_mfma_f32_16x16x32_bf16 v[72:75], v[52:55], v[132:135], v[72:75]
    v_mfma_f32_16x16x32_bf16 v[76:79], v[36:39], v[140:143], v[76:79]
    v_mfma_f32_16x16x32_bf16 v[80:83], v[44:47], v[140:143], v[80:83]
    v_mfma_f32_16x16x32_bf16 v[84:87], v[52:55], v[140:143], v[84:87]
    v_mfma_f32_16x16x32_bf16 v[88:91], v[36:39], v[148:151], v[88:91]
    v_mfma_f32_16x16x32_bf16 v[92:95], v[44:47], v[148:151], v[92:95]
    v_mfma_f32_16x16x32_bf16 v[96:99], v[52:55], v[148:151], v[96:99]
    v_mfma_f32_16x16x32_bf16 v[100:103], v[36:39], v[156:159], v[100:103]
    v_mfma_f32_16x16x32_bf16 v[104:107], v[44:47], v[156:159], v[104:107]
    v_mfma_f32_16x16x32_bf16 v[108:111], v[52:55], v[156:159], v[108:111]
    s_nop 7
    v_cvt_pk_bf16_f32 v112, v72, v72
    v_cvt_pk_bf16_f32 v114, v84, v84
    v_cvt_pk_bf16_f32 v116, v96, v96
    v_cvt_pk_bf16_f32 v118, v108, v108
    v_lshlrev_b32 v112, 16, v112
    v_lshlrev_b32 v114, 16, v114
    v_lshlrev_b32 v116, 16, v116
    v_lshlrev_b32 v118, 16, v118
    v_add_f32 v112, 0x358637bd, v112
    v_add_f32 v114, 0x358637bd, v114
    v_add_f32 v116, 0x358637bd, v116
    v_add_f32 v118, 0x358637bd, v118
    v_cvt_pk_bf16_f32 v112, v112, v112
    v_cvt_pk_bf16_f32 v114, v114, v114
    v_cvt_pk_bf16_f32 v116, v116, v116
    v_cvt_pk_bf16_f32 v118, v118, v118
    v_lshlrev_b32 v112, 16, v112
    v_lshlrev_b32 v114, 16, v114
    v_lshlrev_b32 v116, 16, v116
    v_lshlrev_b32 v118, 16, v118
    v_rcp_f32 v112, v112
    v_rcp_f32 v114, v114
    v_rcp_f32 v116, v116
    v_rcp_f32 v118, v118
    v_cvt_pk_bf16_f32 v16, v64, v65
    v_cvt_pk_bf16_f32 v17, v66, v67
    v_cvt_pk_bf16_f32 v18, v68, v69
    v_cvt_pk_bf16_f32 v19, v70, v71
    v_lshlrev_b32 v64, 16, v16
    v_and_b32 v65, 0xffff0000, v16
    v_lshlrev_b32 v66, 16, v17
    v_and_b32 v67, 0xffff0000, v17
    v_lshlrev_b32 v68, 16, v18
    v_and_b32 v69, 0xffff0000, v18
    v_lshlrev_b32 v70, 16, v19
    v_and_b32 v71, 0xffff0000, v19
    v_pk_mul_f32 v[64:65], v[64:65], v[112:113] op_sel_hi:[1,0]
    v_pk_mul_f32 v[66:67], v[66:67], v[112:113] op_sel_hi:[1,0]
    v_pk_mul_f32 v[68:69], v[68:69], v[112:113] op_sel_hi:[1,0]
    v_pk_mul_f32 v[70:71], v[70:71], v[112:113] op_sel_hi:[1,0]
    v_cvt_pk_bf16_f32 v20, v64, v65
    v_cvt_pk_bf16_f32 v21, v66, v67
    v_cvt_pk_bf16_f32 v22, v68, v69
    v_cvt_pk_bf16_f32 v23, v70, v71
    ds_write_b64 v5, v[20:21] offset:0
    ds_write_b64 v5, v[22:23] offset:32
    v_cvt_pk_bf16_f32 v16, v76, v77
    v_cvt_pk_bf16_f32 v17, v78, v79
    v_cvt_pk_bf16_f32 v18, v80, v81
    v_cvt_pk_bf16_f32 v19, v82, v83
    v_lshlrev_b32 v76, 16, v16
    v_and_b32 v77, 0xffff0000, v16
    v_lshlrev_b32 v78, 16, v17
    v_and_b32 v79, 0xffff0000, v17
    v_lshlrev_b32 v80, 16, v18
    v_and_b32 v81, 0xffff0000, v18
    v_lshlrev_b32 v82, 16, v19
    v_and_b32 v83, 0xffff0000, v19
    v_pk_mul_f32 v[76:77], v[76:77], v[114:115] op_sel_hi:[1,0]
    v_pk_mul_f32 v[78:79], v[78:79], v[114:115] op_sel_hi:[1,0]
    v_pk_mul_f32 v[80:81], v[80:81], v[114:115] op_sel_hi:[1,0]
    v_pk_mul_f32 v[82:83], v[82:83], v[114:115] op_sel_hi:[1,0]
    v_cvt_pk_bf16_f32 v24, v76, v77
    v_cvt_pk_bf16_f32 v25, v78, v79
    v_cvt_pk_bf16_f32 v26, v80, v81
    v_cvt_pk_bf16_f32 v27, v82, v83
    ds_write_b64 v5, v[24:25] offset:1280
    ds_write_b64 v5, v[26:27] offset:1312
    v_cvt_pk_bf16_f32 v16, v88, v89
    v_cvt_pk_bf16_f32 v17, v90, v91
    v_cvt_pk_bf16_f32 v18, v92, v93
    v_cvt_pk_bf16_f32 v19, v94, v95
    v_lshlrev_b32 v88, 16, v16
    v_and_b32 v89, 0xffff0000, v16
    v_lshlrev_b32 v90, 16, v17
    v_and_b32 v91, 0xffff0000, v17
    v_lshlrev_b32 v92, 16, v18
    v_and_b32 v93, 0xffff0000, v18
    v_lshlrev_b32 v94, 16, v19
    v_and_b32 v95, 0xffff0000, v19
    v_pk_mul_f32 v[88:89], v[88:89], v[116:117] op_sel_hi:[1,0]
    v_pk_mul_f32 v[90:91], v[90:91], v[116:117] op_sel_hi:[1,0]
    v_pk_mul_f32 v[92:93], v[92:93], v[116:117] op_sel_hi:[1,0]
    v_pk_mul_f32 v[94:95], v[94:95], v[116:117] op_sel_hi:[1,0]
    v_cvt_pk_bf16_f32 v20, v88, v89
    v_cvt_pk_bf16_f32 v21, v90, v91
    v_cvt_pk_bf16_f32 v22, v92, v93
    v_cvt_pk_bf16_f32 v23, v94, v95
    ds_write_b64 v5, v[20:21] offset:2560
    ds_write_b64 v5, v[22:23] offset:2592
    v_cvt_pk_bf16_f32 v16, v100, v101
    v_cvt_pk_bf16_f32 v17, v102, v103
    v_cvt_pk_bf16_f32 v18, v104, v105
    v_cvt_pk_bf16_f32 v19, v106, v107
    v_lshlrev_b32 v100, 16, v16
    v_and_b32 v101, 0xffff0000, v16
    v_lshlrev_b32 v102, 16, v17
    v_and_b32 v103, 0xffff0000, v17
    v_lshlrev_b32 v104, 16, v18
    v_and_b32 v105, 0xffff0000, v18
    v_lshlrev_b32 v106, 16, v19
    v_and_b32 v107, 0xffff0000, v19
    v_pk_mul_f32 v[100:101], v[100:101], v[118:119] op_sel_hi:[1,0]
    v_pk_mul_f32 v[102:103], v[102:103], v[118:119] op_sel_hi:[1,0]
    v_pk_mul_f32 v[104:105], v[104:105], v[118:119] op_sel_hi:[1,0]
    v_pk_mul_f32 v[106:107], v[106:107], v[118:119] op_sel_hi:[1,0]
    v_cvt_pk_bf16_f32 v24, v100, v101
    v_cvt_pk_bf16_f32 v25, v102, v103
    v_cvt_pk_bf16_f32 v26, v104, v105
    v_cvt_pk_bf16_f32 v27, v106, v107
    ds_write_b64 v5, v[24:25] offset:3840
    ds_write_b64 v5, v[26:27] offset:3872
    s_waitcnt lgkmcnt(0)
    ds_read_b128 v[32:35], v6 offset:0
    ds_read_b128 v[36:39], v6 offset:1280
    ds_read_b128 v[40:43], v6 offset:2560
    ds_read_b128 v[44:47], v6 offset:3840
    s_waitcnt lgkmcnt(3)
    s_mov_b32 s28, 0x0
    buffer_store_dwordx4 v[32:35], v12, s[8:11], s28 offen sc1
    s_waitcnt lgkmcnt(2)
    s_mov_b32 s28, 0x24000
    buffer_store_dwordx4 v[36:39], v12, s[8:11], s28 offen sc1
    s_waitcnt lgkmcnt(1)
    s_mov_b32 s28, 0x48000
    buffer_store_dwordx4 v[40:43], v12, s[8:11], s28 offen sc1
    s_waitcnt lgkmcnt(0)
    s_mov_b32 s28, 0x6c000
    buffer_store_dwordx4 v[44:47], v12, s[8:11], s28 offen sc1
    s_barrier
g2_noapply:
    v_lshrrev_b32 v5, 3, v1
    s_lshl_b32 s28, s24, 7
    s_lshl_b32 s29, s20, 4
    s_add_u32 s28, s28, s29
    v_add_u32 v5, s28, v5
    s_movk_i32 s28, 9216
    v_mul_lo_u32 v5, v5, s28
    v_and_b32 v6, 7, v1
    v_add_u32 v7, 0, v4
    v_and_b32 v7, 7, v7
    v_xor_b32 v7, v7, v6
    v_lshl_add_u32 v7, v7, 4, v5
    v_add_u32 v8, 0, v7
    v_add_u32 v7, 4, v4
    v_and_b32 v7, 7, v7
    v_xor_b32 v7, v7, v6
    v_lshl_add_u32 v7, v7, 4, v5
    v_add_u32 v9, 73728, v7
    s_lshl_b32 s28, s20, 3
    v_add_u32 v5, s28, v4
    v_lshlrev_b32 v5, 11, v5
    s_lshl_b32 s28, s25, 8
    v_add_u32 v5, s28, v5
    s_lshl_b32 s28, s26, 2
    v_or_b32 v7, s28, v4
    v_lshlrev_b32 v7, 1, v7
    v_xor_b32 v7, v7, v3
    v_lshl_add_u32 v12, v7, 4, v5
    v_add_u32 v13, 8192, v12
    s_lshl_b32 s28, s21, 2
    v_add_u32 v5, s28, v4
    v_lshrrev_b32 v6, 1, v3
    v_xor_b32 v5, v5, v6
    s_lshl_b32 s28, s22, 6
    v_add_u32 v6, s28, v3
    v_lshlrev_b32 v6, 7, v6
    v_lshl_add_u32 v16, v5, 4, v6
    v_bfe_u32 v5, v1, 2, 2
    v_and_b32 v6, 1, v4
    v_lshl_or_b32 v6, v6, 2, v5
    v_lshl_add_u32 v5, v4, 3, v5
    s_lshl_b32 s28, s21, 5
    v_add_u32 v5, s28, v5
    v_lshlrev_b32 v5, 8, v5
    v_and_b32 v7, 3, v1
    v_lshl_add_u32 v5, v7, 3, v5
    v_add_u32 v5, 0x10000, v5
    s_lshl_b32 s28, s26, 2
    s_add_u32 s28, s28, 0
    v_xor_b32 v7, s28, v6
    v_lshl_add_u32 v18, v7, 5, v5
    s_lshl_b32 s28, s26, 2
    s_add_u32 s28, s28, 1
    v_xor_b32 v7, s28, v6
    v_lshl_add_u32 v19, v7, 5, v5
    s_lshl_b32 s28, s26, 2
    s_add_u32 s28, s28, 2
    v_xor_b32 v7, s28, v6
    v_lshl_add_u32 v20, v7, 5, v5
    s_lshl_b32 s28, s26, 2
    s_add_u32 s28, s28, 3
    v_xor_b32 v7, s28, v6
    v_lshl_add_u32 v21, v7, 5, v5
    s_mov_b32 s12, s6
    s_mov_b32 s13, s7
    s_and_b32 s13, s13, 0xffff
    s_mov_b32 s14, 0x700000
    s_mov_b32 s15, 0x00020000
    s_and_b32 s31, s31, 0xffff
    s_mul_i32 s16, s23, 3072
    s_mul_i32 s17, s23, 3145728
    s_mov_b32 s19, 1000
    s_mov_b32 s18, 5
    s_cmp_eq_u32 s23, 1
    s_cselect_b32 s19, 32, s19
    s_cselect_b32 s18, 11, s18
    s_cselect_b32 s3, 4, 0
    s_lshr_b32 s28, s24, 1
    s_lshl_b32 s28, s28, 8
    s_add_u32 s28, s28, 32768
    v_mov_b32 v27, s28
    s_add_u32 s40, s4, 0x2400000
    s_addc_u32 s41, s5, 0
    s_and_b32 s41, s41, 0xffff
    s_mov_b32 s42, 0x800000
    s_mov_b32 s43, 0x00020000
    s_lshl_b32 s28, s24, 3
    s_add_u32 s28, s28, s25
    s_lshl_b32 s38, s28, 8
    s_lshl_b32 s39, s28, 16
    s_lshl_b32 s28, s20, 13
    s_add_u32 s39, s39, s28
    v_mov_b32 v22, s38
    v_lshlrev_b32 v24, 4, v1
    v_add_u32 v24, s39, v24
    s_movk_i32 s39, 4096
    s_mov_b32 s48, s32
    s_mov_b32 s49, s33
    s_and_b32 s49, s49, 0xffff
    s_mov_b32 s50, 0x400000
    s_mov_b32 s51, 0x00020000
    s_mov_b32 s52, s34
    s_mov_b32 s53, s35
    s_and_b32 s53, s53, 0xffff
    s_mov_b32 s54, 0x800
    s_mov_b32 s55, 0x00020000
    s_mov_b32 s56, s36
    s_mov_b32 s57, s37
    s_and_b32 s57, s57, 0xffff
    s_mov_b32 s58, 0x400000
    s_mov_b32 s59, 0x00020000
    s_lshl_b32 s28, s24, 7
    s_lshl_b32 s29, s20, 4
    s_add_u32 s28, s28, s29
    v_add_u32 v25, s28, v4
    v_lshlrev_b32 v25, 11, v25
    s_lshl_b32 s28, s25, 8
    v_lshl_add_u32 v26, v3, 4, s28
    v_add_u32 v25, v25, v26
    s_cmp_eq_u32 s19, 0
    s_cselect_b32 s12, s30, s12
    s_cselect_b32 s13, s31, s13
    s_cselect_b32 s14, 0x200000, s14
    s_cselect_b32 s17, 0, s17
    s_sub_u32 s19, s19, 1
    s_add_u32 m0, s27, 0
    s_nop 0
    buffer_load_dwordx4 v8, s[8:11], s16 offen sc1 lds
    s_add_u32 m0, s27, 1024
    s_nop 0
    buffer_load_dwordx4 v9, s[8:11], s16 offen sc1 lds
    s_add_u32 m0, s27, 65536
    s_nop 0
    buffer_load_dwordx4 v12, s[12:15], s17 offen lds
    s_add_u32 m0, s27, 66560
    s_nop 0
    buffer_load_dwordx4 v13, s[12:15], s17 offen lds
    s_add_u32 s16, s16, 128
    s_add_u32 s17, s17, 131072
    s_cmp_eq_u32 s19, 0
    s_cselect_b32 s12, s30, s12
    s_cselect_b32 s13, s31, s13
    s_cselect_b32 s14, 0x200000, s14
    s_cselect_b32 s17, 0, s17
    s_sub_u32 s19, s19, 1
    s_add_u32 m0, s27, 16384
    s_nop 0
    buffer_load_dwordx4 v8, s[8:11], s16 offen sc1 lds
    s_add_u32 m0, s27, 17408
    s_nop 0
    buffer_load_dwordx4 v9, s[8:11], s16 offen sc1 lds
    s_add_u32 m0, s27, 81920
    s_nop 0
    buffer_load_dwordx4 v12, s[12:15], s17 offen lds
    s_add_u32 m0, s27, 82944
    s_nop 0
    buffer_load_dwordx4 v13, s[12:15], s17 offen lds
    s_add_u32 s16, s16, 128
    s_add_u32 s17, s17, 131072
    s_cmp_eq_u32 s19, 0
    s_cselect_b32 s12, s30, s12
    s_cselect_b32 s13, s31, s13
    s_cselect_b32 s14, 0x200000, s14
    s_cselect_b32 s17, 0, s17
    s_sub_u32 s19, s19, 1
    s_add_u32 m0, s27, 32768
    s_nop 0
    buffer_load_dwordx4 v8, s[8:11], s16 offen sc1 lds
    s_add_u32 m0, s27, 33792
    s_nop 0
    buffer_load_dwordx4 v9, s[8:11], s16 offen sc1 lds
    s_add_u32 m0, s27, 98304
    s_nop 0
    buffer_load_dwordx4 v12, s[12:15], s17 offen lds
    s_add_u32 m0, s27, 99328
    s_nop 0
    buffer_load_dwordx4 v13, s[12:15], s17 offen lds
    s_add_u32 s16, s16, 128
    s_add_u32 s17, s17, 131072
    s_cmp_eq_u32 s19, 0
    s_cselect_b32 s12, s30, s12
    s_cselect_b32 s13, s31, s13
    s_cselect_b32 s14, 0x200000, s14
    s_cselect_b32 s17, 0, s17
    s_sub_u32 s19, s19, 1
    s_add_u32 m0, s27, 49152
    s_nop 0
    buffer_load_dwordx4 v8, s[8:11], s16 offen sc1 lds
    s_add_u32 m0, s27, 50176
    s_nop 0
    buffer_load_dwordx4 v9, s[8:11], s16 offen sc1 lds
    s_add_u32 m0, s27, 114688
    s_nop 0
    buffer_load_dwordx4 v12, s[12:15], s17 offen lds
    s_add_u32 m0, s27, 115712
    s_nop 0
    buffer_load_dwordx4 v13, s[12:15], s17 offen lds
    s_add_u32 s16, s16, 128
    s_add_u32 s17, s17, 131072
    v_mov_b32 v128, 0
    v_mov_b32 v129, 0
    v_mov_b32 v130, 0
    v_mov_b32 v131, 0
    v_mov_b32 v132, 0
    v_mov_b32 v133, 0
    v_mov_b32 v134, 0
    v_mov_b32 v135, 0
    v_mov_b32 v136, 0
    v_mov_b32 v137, 0
    v_mov_b32 v138, 0
    v_mov_b32 v139, 0
    v_mov_b32 v140, 0
    v_mov_b32 v141, 0
    v_mov_b32 v142, 0
    v_mov_b32 v143, 0
    v_mov_b32 v144, 0
    v_mov_b32 v145, 0
    v_mov_b32 v146, 0
    v_mov_b32 v147, 0
    v_mov_b32 v148, 0
    v_mov_b32 v149, 0
    v_mov_b32 v150, 0
    v_mov_b32 v151, 0
    v_mov_b32 v152, 0
    v_mov_b32 v153, 0
    v_mov_b32 v154, 0
    v_mov_b32 v155, 0
    v_mov_b32 v156, 0
    v_mov_b32 v157, 0
    v_mov_b32 v158, 0
    v_mov_b32 v159, 0
    v_mov_b32 v160, 0
    v_mov_b32 v161, 0
    v_mov_b32 v162, 0
    v_mov_b32 v163, 0
    v_mov_b32 v164, 0
    v_mov_b32 v165, 0
    v_mov_b32 v166, 0
    v_mov_b32 v167, 0
    v_mov_b32 v168, 0
    v_mov_b32 v169, 0
    v_mov_b32 v170, 0
    v_mov_b32 v171, 0
    v_mov_b32 v172, 0
    v_mov_b32 v173, 0
    v_mov_b32 v174, 0
    v_mov_b32 v175, 0
    v_mov_b32 v176, 0
    v_mov_b32 v177, 0
    v_mov_b32 v178, 0
    v_mov_b32 v179, 0
    v_mov_b32 v180, 0
    v_mov_b32 v181, 0
    v_mov_b32 v182, 0
    v_mov_b32 v183, 0
    v_mov_b32 v184, 0
    v_mov_b32 v185, 0
    v_mov_b32 v186, 0
    v_mov_b32 v187, 0
    v_mov_b32 v188, 0
    v_mov_b32 v189, 0
    v_mov_b32 v190, 0
    v_mov_b32 v191, 0
    s_cmp_lg_u32 s23, 0
    s_cbranch_scc1 g2_nosig
    s_lshr_b32 s28, s2, 4
    s_lshl_b32 s28, s28, 8
    s_add_u32 s28, s28, 32768
    v_mov_b32 v28, s28
    s_waitcnt vmcnt(16)
    s_barrier
    s_cmp_lg_u32 s20, 0
    s_cbranch_scc1 g2_ap_sig
    v_mov_b32 v29, 1
    s_mov_b64 exec, 1
    buffer_atomic_add v29, v28, s[44:47], 0 offen sc1
    s_mov_b64 exec, -1
g2_ap_sig:
g2_nosig:
    s_waitcnt vmcnt(12)
    s_barrier
    ds_read_b128 v[32:35], v16 offset:0
    ds_read_b128 v[36:39], v16 offset:2048
    ds_read_b128 v[40:43], v16 offset:4096
    ds_read_b128 v[44:47], v16 offset:6144
    ds_read_b64_tr_b16 v[48:49], v18 offset:0
    ds_read_b64_tr_b16 v[50:51], v18 offset:1024
    ds_read_b64_tr_b16 v[52:53], v19 offset:0
    ds_read_b64_tr_b16 v[54:55], v19 offset:1024
    ds_read_b64_tr_b16 v[56:57], v20 offset:0
    ds_read_b64_tr_b16 v[58:59], v20 offset:1024
    ds_read_b64_tr_b16 v[60:61], v21 offset:0
    ds_read_b64_tr_b16 v[62:63], v21 offset:1024
    s_waitcnt vmcnt(8) lgkmcnt(0)
    s_barrier
    v_mov_b32 v23, 0
g2_loop:
    s_cmp_eq_u32 s18, s3
    s_cbranch_scc1 g2_opoll
    s_add_u32 s28, s3, 1
    s_cmp_lg_u32 s18, s28
    s_cbranch_scc1 g2_loop2
    buffer_load_dword v23, v27, s[44:47], 0 offen sc1
g2_loop2:
    v_mfma_f32_16x16x32_bf16 v[128:131], v[48:51], v[32:35], v[128:131]
    s_cmp_eq_u32 s19, 0
    s_cselect_b32 s12, s30, s12
    s_cselect_b32 s13, s31, s13
    s_cselect_b32 s14, 0x200000, s14
    s_cselect_b32 s17, 0, s17
    s_sub_u32 s19, s19, 1
    ds_read_b128 v[64:67], v16 offset:16384
    v_mfma_f32_16x16x32_bf16 v[132:135], v[52:55], v[32:35], v[132:135]
    s_add_u32 m0, s27, 0
    s_nop 0
    buffer_load_dwordx4 v8, s[8:11], s16 offen sc1 lds
    v_mfma_f32_16x16x32_bf16 v[136:139], v[56:59], v[32:35], v[136:139]
    ds_read_b128 v[68:71], v16 offset:18432
    v_mfma_f32_16x16x32_bf16 v[140:143], v[60:63], v[32:35], v[140:143]
    ds_read_b128 v[72:75], v16 offset:20480
    v_mfma_f32_16x16x32_bf16 v[144:147], v[48:51], v[36:39], v[144:147]
    ds_read_b128 v[76:79], v16 offset:22528
    v_mfma_f32_16x16x32_bf16 v[148:151], v[52:55], v[36:39], v[148:151]
    s_add_u32 m0, s27, 1024
    s_nop 0
    buffer_load_dwordx4 v9, s[8:11], s16 offen sc1 lds
    v_mfma_f32_16x16x32_bf16 v[152:155], v[56:59], v[36:39], v[152:155]
    ds_read_b64_tr_b16 v[80:81], v18 offset:16384
    v_mfma_f32_16x16x32_bf16 v[156:159], v[60:63], v[36:39], v[156:159]
    ds_read_b64_tr_b16 v[82:83], v18 offset:17408
    v_mfma_f32_16x16x32_bf16 v[160:163], v[48:51], v[40:43], v[160:163]
    ds_read_b64_tr_b16 v[84:85], v19 offset:16384
    v_mfma_f32_16x16x32_bf16 v[164:167], v[52:55], v[40:43], v[164:167]
    s_add_u32 m0, s27, 65536
    s_nop 0
    buffer_load_dwordx4 v12, s[12:15], s17 offen lds
    v_mfma_f32_16x16x32_bf16 v[168:171], v[56:59], v[40:43], v[168:171]
    ds_read_b64_tr_b16 v[86:87], v19 offset:17408
    v_mfma_f32_16x16x32_bf16 v[172:175], v[60:63], v[40:43], v[172:175]
    ds_read_b64_tr_b16 v[88:89], v20 offset:16384
    v_mfma_f32_16x16x32_bf16 v[176:179], v[48:51], v[44:47], v[176:179]
    ds_read_b64_tr_b16 v[90:91], v20 offset:17408
    v_mfma_f32_16x16x32_bf16 v[180:183], v[52:55], v[44:47], v[180:183]
    s_add_u32 m0, s27, 66560
    s_nop 0
    buffer_load_dwordx4 v13, s[12:15], s17 offen lds
    s_add_u32 s16, s16, 128
    s_add_u32 s17, s17, 131072
    v_mfma_f32_16x16x32_bf16 v[184:187], v[56:59], v[44:47], v[184:187]
    ds_read_b64_tr_b16 v[92:93], v21 offset:16384
    v_mfma_f32_16x16x32_bf16 v[188:191], v[60:63], v[44:47], v[188:191]
    ds_read_b64_tr_b16 v[94:95], v21 offset:17408
    s_waitcnt vmcnt(8) lgkmcnt(0)
    s_barrier
    v_mfma_f32_16x16x32_bf16 v[128:131], v[80:83], v[64:67], v[128:131]
    s_cmp_eq_u32 s19, 0
    s_cselect_b32 s12, s30, s12
    s_cselect_b32 s13, s31, s13
    s_cselect_b32 s14, 0x200000, s14
    s_cselect_b32 s17, 0, s17
    s_sub_u32 s19, s19, 1
    ds_read_b128 v[32:35], v16 offset:32768
    v_mfma_f32_16x16x32_bf16 v[132:135], v[84:87], v[64:67], v[132:135]
    s_add_u32 m0, s27, 16384
    s_nop 0
    buffer_load_dwordx4 v8, s[8:11], s16 offen sc1 lds
    v_mfma_f32_16x16x32_bf16 v[136:139], v[88:91], v[64:67], v[136:139]
    ds_read_b128 v[36:39], v16 offset:34816
    v_mfma_f32_16x16x32_bf16 v[140:143], v[92:95], v[64:67], v[140:143]
    ds_read_b128 v[40:43], v16 offset:36864
    v_mfma_f32_16x16x32_bf16 v[144:147], v[80:83], v[68:71], v[144:147]
    ds_read_b128 v[44:47], v16 offset:38912
    v_mfma_f32_16x16x32_bf16 v[148:151], v[84:87], v[68:71], v[148:151]
    s_add_u32 m0, s27, 17408
    s_nop 0
    buffer_load_dwordx4 v9, s[8:11], s16 offen sc1 lds
    v_mfma_f32_16x16x32_bf16 v[152:155], v[88:91], v[68:71], v[152:155]
    ds_read_b64_tr_b16 v[48:49], v18 offset:32768
    v_mfma_f32_16x16x32_bf16 v[156:159], v[92:95], v[68:71], v[156:159]
    ds_read_b64_tr_b16 v[50:51], v18 offset:33792
    v_mfma_f32_16x16x32_bf16 v[160:163], v[80:83], v[72:75], v[160:163]
    ds_read_b64_tr_b16 v[52:53], v19 offset:32768
    v_mfma_f32_16x16x32_bf16 v[164:167], v[84:87], v[72:75], v[164:167]
    s_add_u32 m0, s27, 81920
    s_nop 0
    buffer_load_dwordx4 v12, s[12:15], s17 offen lds
    v_mfma_f32_16x16x32_bf16 v[168:171], v[88:91], v[72:75], v[168:171]
    ds_read_b64_tr_b16 v[54:55], v19 offset:33792
    v_mfma_f32_16x16x32_bf16 v[172:175], v[92:95], v[72:75], v[172:175]
    ds_read_b64_tr_b16 v[56:57], v20 offset:32768
    v_mfma_f32_16x16x32_bf16 v[176:179], v[80:83], v[76:79], v[176:179]
    ds_read_b64_tr_b16 v[58:59], v20 offset:33792
    v_mfma_f32_16x16x32_bf16 v[180:183], v[84:87], v[76:79], v[180:183]
    s_add_u32 m0, s27, 82944
    s_nop 0
    buffer_load_dwordx4 v13, s[12:15], s17 offen lds
    s_add_u32 s16, s16, 128
    s_add_u32 s17, s17, 131072
    v_mfma_f32_16x16x32_bf16 v[184:187], v[88:91], v[76:79], v[184:187]
    ds_read_b64_tr_b16 v[60:61], v21 offset:32768
    v_mfma_f32_16x16x32_bf16 v[188:191], v[92:95], v[76:79], v[188:191]
    ds_read_b64_tr_b16 v[62:63], v21 offset:33792
    s_waitcnt vmcnt(8) lgkmcnt(0)
    s_barrier
    v_mfma_f32_16x16x32_bf16 v[128:131], v[48:51], v[32:35], v[128:131]
    s_cmp_eq_u32 s19, 0
    s_cselect_b32 s12, s30, s12
    s_cselect_b32 s13, s31, s13
    s_cselect_b32 s14, 0x200000, s14
    s_cselect_b32 s17, 0, s17
    s_sub_u32 s19, s19, 1
    ds_read_b128 v[64:67], v16 offset:49152
    v_mfma_f32_16x16x32_bf16 v[132:135], v[52:55], v[32:35], v[132:135]
    s_add_u32 m0, s27, 32768
    s_nop 0
    buffer_load_dwordx4 v8, s[8:11], s16 offen sc1 lds
    v_mfma_f32_16x16x32_bf16 v[136:139], v[56:59], v[32:35], v[136:139]
    ds_read_b128 v[68:71], v16 offset:51200
    v_mfma_f32_16x16x32_bf16 v[140:143], v[60:63], v[32:35], v[140:143]
    ds_read_b128 v[72:75], v16 offset:53248
    v_mfma_f32_16x16x32_bf16 v[144:147], v[48:51], v[36:39], v[144:147]
    ds_read_b128 v[76:79], v16 offset:55296
    v_mfma_f32_16x16x32_bf16 v[148:151], v[52:55], v[36:39], v[148:151]
    s_add_u32 m0, s27, 33792
    s_nop 0
    buffer_load_dwordx4 v9, s[8:11], s16 offen sc1 lds
    v_mfma_f32_16x16x32_bf16 v[152:155], v[56:59], v[36:39], v[152:155]
    ds_read_b64_tr_b16 v[80:81], v18 offset:49152
    v_mfma_f32_16x16x32_bf16 v[156:159], v[60:63], v[36:39], v[156:159]
    ds_read_b64_tr_b16 v[82:83], v18 offset:50176
    v_mfma_f32_16x16x32_bf16 v[160:163], v[48:51], v[40:43], v[160:163]
    ds_read_b64_tr_b16 v[84:85], v19 offset:49152
    v_mfma_f32_16x16x32_bf16 v[164:167], v[52:55], v[40:43], v[164:167]
    s_add_u32 m0, s27, 98304
    s_nop 0
    buffer_load_dwordx4 v12, s[12:15], s17 offen lds
    v_mfma_f32_16x16x32_bf16 v[168:171], v[56:59], v[40:43], v[168:171]
    ds_read_b64_tr_b16 v[86:87], v19 offset:50176
    v_mfma_f32_16x16x32_bf16 v[172:175], v[60:63], v[40:43], v[172:175]
    ds_read_b64_tr_b16 v[88:89], v20 offset:49152
    v_mfma_f32_16x16x32_bf16 v[176:179], v[48:51], v[44:47], v[176:179]
    ds_read_b64_tr_b16 v[90:91], v20 offset:50176
    v_mfma_f32_16x16x32_bf16 v[180:183], v[52:55], v[44:47], v[180:183]
    s_add_u32 m0, s27, 99328
    s_nop 0
    buffer_load_dwordx4 v13, s[12:15], s17 offen lds
    s_add_u32 s16, s16, 128
    s_add_u32 s17, s17, 131072
    v_mfma_f32_16x16x32_bf16 v[184:187], v[56:59], v[44:47], v[184:187]
    ds_read_b64_tr_b16 v[92:93], v21 offset:49152
    v_mfma_f32_16x16x32_bf16 v[188:191], v[60:63], v[44:47], v[188:191]
    ds_read_b64_tr_b16 v[94:95], v21 offset:50176
    s_waitcnt vmcnt(8) lgkmcnt(0)
    s_barrier
    v_mfma_f32_16x16x32_bf16 v[128:131], v[80:83], v[64:67], v[128:131]
    s_cmp_eq_u32 s19, 0
    s_cselect_b32 s12, s30, s12
    s_cselect_b32 s13, s31, s13
    s_cselect_b32 s14, 0x200000, s14
    s_cselect_b32 s17, 0, s17
    s_sub_u32 s19, s19, 1
    ds_read_b128 v[32:35], v16 offset:0
    v_mfma_f32_16x16x32_bf16 v[132:135], v[84:87], v[64:67], v[132:135]
    s_add_u32 m0, s27, 49152
    s_nop 0
    buffer_load_dwordx4 v8, s[8:11], s16 offen sc1 lds
    v_mfma_f32_16x16x32_bf16 v[136:139], v[88:91], v[64:67], v[136:139]
    ds_read_b128 v[36:39], v16 offset:2048
    v_mfma_f32_16x16x32_bf16 v[140:143], v[92:95], v[64:67], v[140:143]
    ds_read_b128 v[40:43], v16 offset:4096
    v_mfma_f32_16x16x32_bf16 v[144:147], v[80:83], v[68:71], v[144:147]
    ds_read_b128 v[44:47], v16 offset:6144
    v_mfma_f32_16x16x32_bf16 v[148:151], v[84:87], v[68:71], v[148:151]
    s_add_u32 m0, s27, 50176
    s_nop 0
    buffer_load_dwordx4 v9, s[8:11], s16 offen sc1 lds
    v_mfma_f32_16x16x32_bf16 v[152:155], v[88:91], v[68:71], v[152:155]
    ds_read_b64_tr_b16 v[48:49], v18 offset:0
    v_mfma_f32_16x16x32_bf16 v[156:159], v[92:95], v[68:71], v[156:159]
    ds_read_b64_tr_b16 v[50:51], v18 offset:1024
    v_mfma_f32_16x16x32_bf16 v[160:163], v[80:83], v[72:75], v[160:163]
    ds_read_b64_tr_b16 v[52:53], v19 offset:0
    v_mfma_f32_16x16x32_bf16 v[164:167], v[84:87], v[72:75], v[164:167]
    s_add_u32 m0, s27, 114688
    s_nop 0
    buffer_load_dwordx4 v12, s[12:15], s17 offen lds
    v_mfma_f32_16x16x32_bf16 v[168:171], v[88:91], v[72:75], v[168:171]
    ds_read_b64_tr_b16 v[54:55], v19 offset:1024
    v_mfma_f32_16x16x32_bf16 v[172:175], v[92:95], v[72:75], v[172:175]
    ds_read_b64_tr_b16 v[56:57], v20 offset:0
    v_mfma_f32_16x16x32_bf16 v[176:179], v[80:83], v[76:79], v[176:179]
    ds_read_b64_tr_b16 v[58:59], v20 offset:1024
    v_mfma_f32_16x16x32_bf16 v[180:183], v[84:87], v[76:79], v[180:183]
    s_add_u32 m0, s27, 115712
    s_nop 0
    buffer_load_dwordx4 v13, s[12:15], s17 offen lds
    s_add_u32 s16, s16, 128
    s_add_u32 s17, s17, 131072
    v_mfma_f32_16x16x32_bf16 v[184:187], v[88:91], v[76:79], v[184:187]
    ds_read_b64_tr_b16 v[60:61], v21 offset:0
    v_mfma_f32_16x16x32_bf16 v[188:191], v[92:95], v[76:79], v[188:191]
    ds_read_b64_tr_b16 v[62:63], v21 offset:1024
    s_waitcnt vmcnt(8) lgkmcnt(0)
    s_barrier
    s_sub_u32 s18, s18, 1
    s_cmp_lg_u32 s18, 0
    s_cbranch_scc1 g2_loop
    buffer_load_dword v23, v22, s[44:47], 0 offen sc1
    v_mfma_f32_16x16x32_bf16 v[128:131], v[48:51], v[32:35], v[128:131]
    ds_read_b128 v[64:67], v16 offset:16384
    v_mfma_f32_16x16x32_bf16 v[132:135], v[52:55], v[32:35], v[132:135]
    v_mfma_f32_16x16x32_bf16 v[136:139], v[56:59], v[32:35], v[136:139]
    ds_read_b128 v[68:71], v16 offset:18432
    v_mfma_f32_16x16x32_bf16 v[140:143], v[60:63], v[32:35], v[140:143]
    ds_read_b128 v[72:75], v16 offset:20480
    v_mfma_f32_16x16x32_bf16 v[144:147], v[48:51], v[36:39], v[144:147]
    ds_read_b128 v[76:79], v16 offset:22528
    v_mfma_f32_16x16x32_bf16 v[148:151], v[52:55], v[36:39], v[148:151]
    v_mfma_f32_16x16x32_bf16 v[152:155], v[56:59], v[36:39], v[152:155]
    ds_read_b64_tr_b16 v[80:81], v18 offset:16384
    v_mfma_f32_16x16x32_bf16 v[156:159], v[60:63], v[36:39], v[156:159]
    ds_read_b64_tr_b16 v[82:83], v18 offset:17408
    v_mfma_f32_16x16x32_bf16 v[160:163], v[48:51], v[40:43], v[160:163]
    ds_read_b64_tr_b16 v[84:85], v19 offset:16384
    v_mfma_f32_16x16x32_bf16 v[164:167], v[52:55], v[40:43], v[164:167]
    v_mfma_f32_16x16x32_bf16 v[168:171], v[56:59], v[40:43], v[168:171]
    ds_read_b64_tr_b16 v[86:87], v19 offset:17408
    v_mfma_f32_16x16x32_bf16 v[172:175], v[60:63], v[40:43], v[172:175]
    ds_read_b64_tr_b16 v[88:89], v20 offset:16384
    v_mfma_f32_16x16x32_bf16 v[176:179], v[48:51], v[44:47], v[176:179]
    ds_read_b64_tr_b16 v[90:91], v20 offset:17408
    v_mfma_f32_16x16x32_bf16 v[180:183], v[52:55], v[44:47], v[180:183]
    v_mfma_f32_16x16x32_bf16 v[184:187], v[56:59], v[44:47], v[184:187]
    ds_read_b64_tr_b16 v[92:93], v21 offset:16384
    v_mfma_f32_16x16x32_bf16 v[188:191], v[60:63], v[44:47], v[188:191]
    ds_read_b64_tr_b16 v[94:95], v21 offset:17408
    s_waitcnt vmcnt(5) lgkmcnt(0)
    s_barrier
    s_cmp_eq_u32 s23, 0
    s_cbranch_scc1 g2_pubtail
    s_mov_b32 s38, 0x0
    buffer_load_dwordx4 v[224:227], v25, s[48:51], s38 offen
    s_mov_b32 s38, 0x2000
    buffer_load_dwordx4 v[228:231], v25, s[48:51], s38 offen
    s_mov_b32 s38, 0x4000
    buffer_load_dwordx4 v[232:235], v25, s[48:51], s38 offen
    s_mov_b32 s38, 0x6000
    buffer_load_dwordx4 v[236:239], v25, s[48:51], s38 offen
    buffer_load_dwordx4 v[240:243], v26, s[52:55], 0 offen
    v_mfma_f32_16x16x32_bf16 v[128:131], v[80:83], v[64:67], v[128:131]
    ds_read_b128 v[32:35], v16 offset:32768
    v_mfma_f32_16x16x32_bf16 v[132:135], v[84:87], v[64:67], v[132:135]
    v_mfma_f32_16x16x32_bf16 v[136:139], v[88:91], v[64:67], v[136:139]
    ds_read_b128 v[36:39], v16 offset:34816
    v_mfma_f32_16x16x32_bf16 v[140:143], v[92:95], v[64:67], v[140:143]
    ds_read_b128 v[40:43], v16 offset:36864
    v_mfma_f32_16x16x32_bf16 v[144:147], v[80:83], v[68:71], v[144:147]
    ds_read_b128 v[44:47], v16 offset:38912
    v_mfma_f32_16x16x32_bf16 v[148:151], v[84:87], v[68:71], v[148:151]
    v_mfma_f32_16x16x32_bf16 v[152:155], v[88:91], v[68:71], v[152:155]
    ds_read_b64_tr_b16 v[48:49], v18 offset:32768
    v_mfma_f32_16x16x32_bf16 v[156:159], v[92:95], v[68:71], v[156:159]
    ds_read_b64_tr_b16 v[50:51], v18 offset:33792
    v_mfma_f32_16x16x32_bf16 v[160:163], v[80:83], v[72:75], v[160:163]
    ds_read_b64_tr_b16 v[52:53], v19 offset:32768
    v_mfma_f32_16x16x32_bf16 v[164:167], v[84:87], v[72:75], v[164:167]
    v_mfma_f32_16x16x32_bf16 v[168:171], v[88:91], v[72:75], v[168:171]
    ds_read_b64_tr_b16 v[54:55], v19 offset:33792
    v_mfma_f32_16x16x32_bf16 v[172:175], v[92:95], v[72:75], v[172:175]
    ds_read_b64_tr_b16 v[56:57], v20 offset:32768
    v_mfma_f32_16x16x32_bf16 v[176:179], v[80:83], v[76:79], v[176:179]
    ds_read_b64_tr_b16 v[58:59], v20 offset:33792
    v_mfma_f32_16x16x32_bf16 v[180:183], v[84:87], v[76:79], v[180:183]
    v_mfma_f32_16x16x32_bf16 v[184:187], v[88:91], v[76:79], v[184:187]
    ds_read_b64_tr_b16 v[60:61], v21 offset:32768
    v_mfma_f32_16x16x32_bf16 v[188:191], v[92:95], v[76:79], v[188:191]
    ds_read_b64_tr_b16 v[62:63], v21 offset:33792
    s_waitcnt vmcnt(5) lgkmcnt(0)
    s_barrier
    s_mov_b32 s29, 0
    s_branch g2_chk
g2_spin:
    buffer_load_dword v23, v22, s[44:47], 0 offen sc1
    s_waitcnt vmcnt(0)
g2_chk:
    v_readfirstlane_b32 s28, v23
    s_add_u32 s29, s29, 1
    s_cmp_ge_u32 s28, 1
    s_cbranch_scc1 g2_go
    s_sleep 2
    s_cmp_lt_u32 s29, 0x100000
    s_cbranch_scc1 g2_spin
g2_go:
    buffer_load_dwordx4 v[192:195], v24, s[40:43], 0 offen offset:0 sc1
    buffer_load_dwordx4 v[196:199], v24, s[40:43], 0 offen offset:1024 sc1
    buffer_load_dwordx4 v[200:203], v24, s[40:43], 0 offen offset:2048 sc1
    buffer_load_dwordx4 v[204:207], v24, s[40:43], 0 offen offset:3072 sc1
    buffer_load_dwordx4 v[208:211], v24, s[40:43], s39 offen offset:0 sc1
    buffer_load_dwordx4 v[212:215], v24, s[40:43], s39 offen offset:1024 sc1
    buffer_load_dwordx4 v[216:219], v24, s[40:43], s39 offen offset:2048 sc1
    buffer_load_dwordx4 v[220:223], v24, s[40:43], s39 offen offset:3072 sc1
    s_branch g2_tail
g2_pubtail:
    v_mfma_f32_16x16x32_bf16 v[128:131], v[80:83], v[64:67], v[128:131]
    ds_read_b128 v[32:35], v16 offset:32768
    v_mfma_f32_16x16x32_bf16 v[132:135], v[84:87], v[64:67], v[132:135]
    v_mfma_f32_16x16x32_bf16 v[136:139], v[88:91], v[64:67], v[136:139]
    ds_read_b128 v[36:39], v16 offset:34816
    v_mfma_f32_16x16x32_bf16 v[140:143], v[92:95], v[64:67], v[140:143]
    ds_read_b128 v[40:43], v16 offset:36864
    v_mfma_f32_16x16x32_bf16 v[144:147], v[80:83], v[68:71], v[144:147]
    ds_read_b128 v[44:47], v16 offset:38912
    v_mfma_f32_16x16x32_bf16 v[148:151], v[84:87], v[68:71], v[148:151]
    v_mfma_f32_16x16x32_bf16 v[152:155], v[88:91], v[68:71], v[152:155]
    ds_read_b64_tr_b16 v[48:49], v18 offset:32768
    v_mfma_f32_16x16x32_bf16 v[156:159], v[92:95], v[68:71], v[156:159]
    ds_read_b64_tr_b16 v[50:51], v18 offset:33792
    v_mfma_f32_16x16x32_bf16 v[160:163], v[80:83], v[72:75], v[160:163]
    ds_read_b64_tr_b16 v[52:53], v19 offset:32768
    v_mfma_f32_16x16x32_bf16 v[164:167], v[84:87], v[72:75], v[164:167]
    v_mfma_f32_16x16x32_bf16 v[168:171], v[88:91], v[72:75], v[168:171]
    ds_read_b64_tr_b16 v[54:55], v19 offset:33792
    v_mfma_f32_16x16x32_bf16 v[172:175], v[92:95], v[72:75], v[172:175]
    ds_read_b64_tr_b16 v[56:57], v20 offset:32768
    v_mfma_f32_16x16x32_bf16 v[176:179], v[80:83], v[76:79], v[176:179]
    ds_read_b64_tr_b16 v[58:59], v20 offset:33792
    v_mfma_f32_16x16x32_bf16 v[180:183], v[84:87], v[76:79], v[180:183]
    v_mfma_f32_16x16x32_bf16 v[184:187], v[88:91], v[76:79], v[184:187]
    ds_read_b64_tr_b16 v[60:61], v21 offset:32768
    v_mfma_f32_16x16x32_bf16 v[188:191], v[92:95], v[76:79], v[188:191]
    ds_read_b64_tr_b16 v[62:63], v21 offset:33792
    s_waitcnt vmcnt(0) lgkmcnt(0)
    s_barrier
g2_tail:
    v_mfma_f32_16x16x32_bf16 v[128:131], v[48:51], v[32:35], v[128:131]
    ds_read_b128 v[64:67], v16 offset:49152
    v_mfma_f32_16x16x32_bf16 v[132:135], v[52:55], v[32:35], v[132:135]
    v_mfma_f32_16x16x32_bf16 v[136:139], v[56:59], v[32:35], v[136:139]
    ds_read_b128 v[68:71], v16 offset:51200
    v_mfma_f32_16x16x32_bf16 v[140:143], v[60:63], v[32:35], v[140:143]
    ds_read_b128 v[72:75], v16 offset:53248
    v_mfma_f32_16x16x32_bf16 v[144:147], v[48:51], v[36:39], v[144:147]
    ds_read_b128 v[76:79], v16 offset:55296
    v_mfma_f32_16x16x32_bf16 v[148:151], v[52:55], v[36:39], v[148:151]
    v_mfma_f32_16x16x32_bf16 v[152:155], v[56:59], v[36:39], v[152:155]
    ds_read_b64_tr_b16 v[80:81], v18 offset:49152
    v_mfma_f32_16x16x32_bf16 v[156:159], v[60:63], v[36:39], v[156:159]
    ds_read_b64_tr_b16 v[82:83], v18 offset:50176
    v_mfma_f32_16x16x32_bf16 v[160:163], v[48:51], v[40:43], v[160:163]
    ds_read_b64_tr_b16 v[84:85], v19 offset:49152
    v_mfma_f32_16x16x32_bf16 v[164:167], v[52:55], v[40:43], v[164:167]
    v_mfma_f32_16x16x32_bf16 v[168:171], v[56:59], v[40:43], v[168:171]
    ds_read_b64_tr_b16 v[86:87], v19 offset:50176
    v_mfma_f32_16x16x32_bf16 v[172:175], v[60:63], v[40:43], v[172:175]
    ds_read_b64_tr_b16 v[88:89], v20 offset:49152
    v_mfma_f32_16x16x32_bf16 v[176:179], v[48:51], v[44:47], v[176:179]
    ds_read_b64_tr_b16 v[90:91], v20 offset:50176
    v_mfma_f32_16x16x32_bf16 v[180:183], v[52:55], v[44:47], v[180:183]
    v_mfma_f32_16x16x32_bf16 v[184:187], v[56:59], v[44:47], v[184:187]
    ds_read_b64_tr_b16 v[92:93], v21 offset:49152
    v_mfma_f32_16x16x32_bf16 v[188:191], v[60:63], v[44:47], v[188:191]
    ds_read_b64_tr_b16 v[94:95], v21 offset:50176
    s_waitcnt lgkmcnt(0)
    s_barrier
    v_mfma_f32_16x16x32_bf16 v[128:131], v[80:83], v[64:67], v[128:131]
    v_mfma_f32_16x16x32_bf16 v[132:135], v[84:87], v[64:67], v[132:135]
    v_mfma_f32_16x16x32_bf16 v[136:139], v[88:91], v[64:67], v[136:139]
    v_mfma_f32_16x16x32_bf16 v[140:143], v[92:95], v[64:67], v[140:143]
    v_mfma_f32_16x16x32_bf16 v[144:147], v[80:83], v[68:71], v[144:147]
    v_mfma_f32_16x16x32_bf16 v[148:151], v[84:87], v[68:71], v[148:151]
    v_mfma_f32_16x16x32_bf16 v[152:155], v[88:91], v[68:71], v[152:155]
    v_mfma_f32_16x16x32_bf16 v[156:159], v[92:95], v[68:71], v[156:159]
    v_mfma_f32_16x16x32_bf16 v[160:163], v[80:83], v[72:75], v[160:163]
    v_mfma_f32_16x16x32_bf16 v[164:167], v[84:87], v[72:75], v[164:167]
    v_mfma_f32_16x16x32_bf16 v[168:171], v[88:91], v[72:75], v[168:171]
    v_mfma_f32_16x16x32_bf16 v[172:175], v[92:95], v[72:75], v[172:175]
    v_mfma_f32_16x16x32_bf16 v[176:179], v[80:83], v[76:79], v[176:179]
    v_mfma_f32_16x16x32_bf16 v[180:183], v[84:87], v[76:79], v[180:183]
    v_mfma_f32_16x16x32_bf16 v[184:187], v[88:91], v[76:79], v[184:187]
    v_mfma_f32_16x16x32_bf16 v[188:191], v[92:95], v[76:79], v[188:191]
    s_nop 7
    s_barrier
    s_mul_i32 s28, s21, 67584
    s_mul_i32 s29, s22, 33792
    s_add_u32 s28, s28, s29
    s_lshl_b32 s29, s26, 8
    s_add_u32 s28, s28, s29
    s_movk_i32 s29, 528
    v_mul_lo_u32 v6, v3, s29
    v_lshl_add_u32 v6, v4, 4, v6
    v_add_u32 v6, s28, v6
    ds_write_b128 v6, v[128:131] offset:0
    ds_write_b128 v6, v[132:135] offset:64
    ds_write_b128 v6, v[136:139] offset:128
    ds_write_b128 v6, v[140:143] offset:192
    ds_write_b128 v6, v[144:147] offset:8448
    ds_write_b128 v6, v[148:151] offset:8512
    ds_write_b128 v6, v[152:155] offset:8576
    ds_write_b128 v6, v[156:159] offset:8640
    ds_write_b128 v6, v[160:163] offset:16896
    ds_write_b128 v6, v[164:167] offset:16960
    ds_write_b128 v6, v[168:171] offset:17024
    ds_write_b128 v6, v[172:175] offset:17088
    ds_write_b128 v6, v[176:179] offset:25344
    ds_write_b128 v6, v[180:183] offset:25408
    ds_write_b128 v6, v[184:187] offset:25472
    ds_write_b128 v6, v[188:191] offset:25536
    s_lshl_b32 s28, s20, 4
    v_add_u32 v7, s28, v4
    v_mul_lo_u32 v7, v7, s29
    v_lshl_add_u32 v7, v3, 5, v7
    v_add_u32 v6, 67584, v7
    s_waitcnt lgkmcnt(0)
    s_barrier
    ds_read_b128 v[128:131], v7 offset:0
    ds_read_b128 v[32:35], v6 offset:0
    ds_read_b128 v[132:135], v7 offset:16
    ds_read_b128 v[36:39], v6 offset:16
    ds_read_b128 v[136:139], v7 offset:2112
    ds_read_b128 v[40:43], v6 offset:2112
    ds_read_b128 v[140:143], v7 offset:2128
    ds_read_b128 v[44:47], v6 offset:2128
    ds_read_b128 v[144:147], v7 offset:4224
    ds_read_b128 v[48:51], v6 offset:4224
    ds_read_b128 v[148:151], v7 offset:4240
    ds_read_b128 v[52:55], v6 offset:4240
    ds_read_b128 v[152:155], v7 offset:6336
    ds_read_b128 v[56:59], v6 offset:6336
    ds_read_b128 v[156:159], v7 offset:6352
    ds_read_b128 v[60:63], v6 offset:6352
    s_waitcnt lgkmcnt(0)
    v_add_f32 v128, v128, v32
    v_add_f32 v129, v129, v33
    v_add_f32 v130, v130, v34
    v_add_f32 v131, v131, v35
    v_add_f32 v132, v132, v36
    v_add_f32 v133, v133, v37
    v_add_f32 v134, v134, v38
    v_add_f32 v135, v135, v39
    v_add_f32 v136, v136, v40
    v_add_f32 v137, v137, v41
    v_add_f32 v138, v138, v42
    v_add_f32 v139, v139, v43
    v_add_f32 v140, v140, v44
    v_add_f32 v141, v141, v45
    v_add_f32 v142, v142, v46
    v_add_f32 v143, v143, v47
    v_add_f32 v144, v144, v48
    v_add_f32 v145, v145, v49
    v_add_f32 v146, v146, v50
    v_add_f32 v147, v147, v51
    v_add_f32 v148, v148, v52
    v_add_f32 v149, v149, v53
    v_add_f32 v150, v150, v54
    v_add_f32 v151, v151, v55
    v_add_f32 v152, v152, v56
    v_add_f32 v153, v153, v57
    v_add_f32 v154, v154, v58
    v_add_f32 v155, v155, v59
    v_add_f32 v156, v156, v60
    v_add_f32 v157, v157, v61
    v_add_f32 v158, v158, v62
    v_add_f32 v159, v159, v63
    s_cmp_lg_u32 s23, 0
    s_cbranch_scc1 g2_second
    buffer_store_dwordx4 v[128:131], v24, s[40:43], 0 offen offset:0 sc1
    buffer_store_dwordx4 v[132:135], v24, s[40:43], 0 offen offset:1024 sc1
    buffer_store_dwordx4 v[136:139], v24, s[40:43], 0 offen offset:2048 sc1
    buffer_store_dwordx4 v[140:143], v24, s[40:43], 0 offen offset:3072 sc1
    buffer_store_dwordx4 v[144:147], v24, s[40:43], s39 offen offset:0 sc1
    buffer_store_dwordx4 v[148:151], v24, s[40:43], s39 offen offset:1024 sc1
    buffer_store_dwordx4 v[152:155], v24, s[40:43], s39 offen offset:2048 sc1
    buffer_store_dwordx4 v[156:159], v24, s[40:43], s39 offen offset:3072 sc1
    s_waitcnt vmcnt(0)
    s_barrier
    s_cmp_lg_u32 s20, 0
    s_cbranch_scc1 g2_fin
    v_mov_b32 v23, 1
    s_mov_b64 exec, 1
    buffer_atomic_add v23, v22, s[44:47], 0 offen sc1
    s_mov_b64 exec, -1
    s_branch g2_fin
g2_second:
    s_waitcnt vmcnt(0)
    v_lshlrev_b32 v32, 16, v240
    v_and_b32 v33, 0xffff0000, v240
    v_lshlrev_b32 v34, 16, v241
    v_and_b32 v35, 0xffff0000, v241
    v_lshlrev_b32 v36, 16, v242
    v_and_b32 v37, 0xffff0000, v242
    v_lshlrev_b32 v38, 16, v243
    v_and_b32 v39, 0xffff0000, v243
    v_lshlrev_b32 v12, 16, v224
    v_and_b32 v13, 0xffff0000, v224
    v_add_f32 v12, v12, v32
    v_add_f32 v13, v13, v33
    v_add_f32 v128, v128, v192
    v_add_f32 v129, v129, v193
    v_add_f32 v128, v128, v12
    v_add_f32 v129, v129, v13
    v_cvt_pk_bf16_f32 v64, v128, v129
    v_lshlrev_b32 v12, 16, v225
    v_and_b32 v13, 0xffff0000, v225
    v_add_f32 v12, v12, v34
    v_add_f32 v13, v13, v35
    v_add_f32 v130, v130, v194
    v_add_f32 v131, v131, v195
    v_add_f32 v130, v130, v12
    v_add_f32 v131, v131, v13
    v_cvt_pk_bf16_f32 v65, v130, v131
    v_lshlrev_b32 v12, 16, v226
    v_and_b32 v13, 0xffff0000, v226
    v_add_f32 v12, v12, v36
    v_add_f32 v13, v13, v37
    v_add_f32 v132, v132, v196
    v_add_f32 v133, v133, v197
    v_add_f32 v132, v132, v12
    v_add_f32 v133, v133, v13
    v_cvt_pk_bf16_f32 v66, v132, v133
    v_lshlrev_b32 v12, 16, v227
    v_and_b32 v13, 0xffff0000, v227
    v_add_f32 v12, v12, v38
    v_add_f32 v13, v13, v39
    v_add_f32 v134, v134, v198
    v_add_f32 v135, v135, v199
    v_add_f32 v134, v134, v12
    v_add_f32 v135, v135, v13
    v_cvt_pk_bf16_f32 v67, v134, v135
    s_mov_b32 s38, 0x0
    buffer_store_dwordx4 v[64:67], v25, s[56:59], s38 offen
    v_lshlrev_b32 v12, 16, v228
    v_and_b32 v13, 0xffff0000, v228
    v_add_f32 v12, v12, v32
    v_add_f32 v13, v13, v33
    v_add_f32 v136, v136, v200
    v_add_f32 v137, v137, v201
    v_add_f32 v136, v136, v12
    v_add_f32 v137, v137, v13
    v_cvt_pk_bf16_f32 v68, v136, v137
    v_lshlrev_b32 v12, 16, v229
    v_and_b32 v13, 0xffff0000, v229
    v_add_f32 v12, v12, v34
    v_add_f32 v13, v13, v35
    v_add_f32 v138, v138, v202
    v_add_f32 v139, v139, v203
    v_add_f32 v138, v138, v12
    v_add_f32 v139, v139, v13
    v_cvt_pk_bf16_f32 v69, v138, v139
    v_lshlrev_b32 v12, 16, v230
    v_and_b32 v13, 0xffff0000, v230
    v_add_f32 v12, v12, v36
    v_add_f32 v13, v13, v37
    v_add_f32 v140, v140, v204
    v_add_f32 v141, v141, v205
    v_add_f32 v140, v140, v12
    v_add_f32 v141, v141, v13
    v_cvt_pk_bf16_f32 v70, v140, v141
    v_lshlrev_b32 v12, 16, v231
    v_and_b32 v13, 0xffff0000, v231
    v_add_f32 v12, v12, v38
    v_add_f32 v13, v13, v39
    v_add_f32 v142, v142, v206
    v_add_f32 v143, v143, v207
    v_add_f32 v142, v142, v12
    v_add_f32 v143, v143, v13
    v_cvt_pk_bf16_f32 v71, v142, v143
    s_mov_b32 s38, 0x2000
    buffer_store_dwordx4 v[68:71], v25, s[56:59], s38 offen
    v_lshlrev_b32 v12, 16, v232
    v_and_b32 v13, 0xffff0000, v232
    v_add_f32 v12, v12, v32
    v_add_f32 v13, v13, v33
    v_add_f32 v144, v144, v208
    v_add_f32 v145, v145, v209
    v_add_f32 v144, v144, v12
    v_add_f32 v145, v145, v13
    v_cvt_pk_bf16_f32 v72, v144, v145
    v_lshlrev_b32 v12, 16, v233
    v_and_b32 v13, 0xffff0000, v233
    v_add_f32 v12, v12, v34
    v_add_f32 v13, v13, v35
    v_add_f32 v146, v146, v210
    v_add_f32 v147, v147, v211
    v_add_f32 v146, v146, v12
    v_add_f32 v147, v147, v13
    v_cvt_pk_bf16_f32 v73, v146, v147
    v_lshlrev_b32 v12, 16, v234
    v_and_b32 v13, 0xffff0000, v234
    v_add_f32 v12, v12, v36
    v_add_f32 v13, v13, v37
    v_add_f32 v148, v148, v212
    v_add_f32 v149, v149, v213
    v_add_f32 v148, v148, v12
    v_add_f32 v149, v149, v13
    v_cvt_pk_bf16_f32 v74, v148, v149
    v_lshlrev_b32 v12, 16, v235
    v_and_b32 v13, 0xffff0000, v235
    v_add_f32 v12, v12, v38
    v_add_f32 v13, v13, v39
    v_add_f32 v150, v150, v214
    v_add_f32 v151, v151, v215
    v_add_f32 v150, v150, v12
    v_add_f32 v151, v151, v13
    v_cvt_pk_bf16_f32 v75, v150, v151
    s_mov_b32 s38, 0x4000
    buffer_store_dwordx4 v[72:75], v25, s[56:59], s38 offen
    v_lshlrev_b32 v12, 16, v236
    v_and_b32 v13, 0xffff0000, v236
    v_add_f32 v12, v12, v32
    v_add_f32 v13, v13, v33
    v_add_f32 v152, v152, v216
    v_add_f32 v153, v153, v217
    v_add_f32 v152, v152, v12
    v_add_f32 v153, v153, v13
    v_cvt_pk_bf16_f32 v76, v152, v153
    v_lshlrev_b32 v12, 16, v237
    v_and_b32 v13, 0xffff0000, v237
    v_add_f32 v12, v12, v34
    v_add_f32 v13, v13, v35
    v_add_f32 v154, v154, v218
    v_add_f32 v155, v155, v219
    v_add_f32 v154, v154, v12
    v_add_f32 v155, v155, v13
    v_cvt_pk_bf16_f32 v77, v154, v155
    v_lshlrev_b32 v12, 16, v238
    v_and_b32 v13, 0xffff0000, v238
    v_add_f32 v12, v12, v36
    v_add_f32 v13, v13, v37
    v_add_f32 v156, v156, v220
    v_add_f32 v157, v157, v221
    v_add_f32 v156, v156, v12
    v_add_f32 v157, v157, v13
    v_cvt_pk_bf16_f32 v78, v156, v157
    v_lshlrev_b32 v12, 16, v239
    v_and_b32 v13, 0xffff0000, v239
    v_add_f32 v12, v12, v38
    v_add_f32 v13, v13, v39
    v_add_f32 v158, v158, v222
    v_add_f32 v159, v159, v223
    v_add_f32 v158, v158, v12
    v_add_f32 v159, v159, v13
    v_cvt_pk_bf16_f32 v79, v158, v159
    s_mov_b32 s38, 0x6000
    buffer_store_dwordx4 v[76:79], v25, s[56:59], s38 offen
g2_fin:
g2_done:
    s_endpgm
g2_opoll:
    s_mov_b32 s29, 0
    s_branch g2_ochk
g2_ospin:
    buffer_load_dword v23, v27, s[44:47], 0 offen sc1
    s_waitcnt vmcnt(0)
g2_ochk:
    v_readfirstlane_b32 s28, v23
    s_add_u32 s29, s29, 1
    s_cmp_ge_u32 s28, 16
    s_cbranch_scc1 g2_loop2
    s_sleep 2
    s_cmp_lt_u32 s29, 0x100000
    s_cbranch_scc1 g2_ospin
    s_branch g2_loop2
.section .rodata,"a"
.p2align 6
.amdhsa_kernel gemm1_kernel
  .amdhsa_next_free_vgpr 256
  .amdhsa_next_free_sgpr 102
  .amdhsa_accum_offset 256
  .amdhsa_group_segment_fixed_size 0
  .amdhsa_kernarg_size 96
  .amdhsa_user_sgpr_count 2
  .amdhsa_user_sgpr_kernarg_segment_ptr 1
  .amdhsa_system_sgpr_workgroup_id_x 1
.end_amdhsa_kernel

.p2align 6
.amdhsa_kernel gemm2_kernel
  .amdhsa_next_free_vgpr 248
  .amdhsa_next_free_sgpr 102
  .amdhsa_accum_offset 248
  .amdhsa_group_segment_fixed_size 0
  .amdhsa_kernarg_size 96
  .amdhsa_user_sgpr_count 2
  .amdhsa_user_sgpr_kernarg_segment_ptr 1
  .amdhsa_system_sgpr_workgroup_id_x 1
.end_amdhsa_kernel
```
